```python
import torch

def _softmax(x, axis=-1):
    return torch.softmax(x, dim=axis)
def _gelu(x):
    return torch.nn.functional.gelu(x, approximate="tanh")
def _silu(x):
    return torch.nn.functional.silu(x)
def _sigmoid(x):
    return torch.sigmoid(x)
def _layernorm(x, axis=-1, eps=1e-5):
    m = x.mean(dim=axis, keepdim=True)
    v = x.var(dim=axis, keepdim=True, unbiased=False)
    return (x - m) / torch.sqrt(v + eps)
def _scatter_add(tgt, idx, src, axis=0):
    return tgt.clone().index_add_(axis, idx, src)
def _segment_sum(src, seg, n):
    out = torch.zeros((n,) + src.shape[1:], dtype=src.dtype)
    return out.index_add_(0, seg, src)
def _pad(x, pw):
    flat = tuple(v for pair in reversed(pw) for v in pair)
    return torch.nn.functional.pad(x, flat)

kernel_name = 'sequential_preLN__softmax_full_mha__glu_gated_swiglu__prompt'

def setup_inputs():

    _w = (lambda a: (lambda t: t.to(torch.bfloat16) if t.is_floating_point() else t)(torch.as_tensor(a)))
    def _A_setup():
        B, S, D = 1, 2048, 512
        return {
            "x": _w((lambda *s: torch.randn(*s, dtype=torch.bfloat16) * 0.05)(B, S, D)),
            "wqkv": _w((lambda *s: torch.randn(*s, dtype=torch.bfloat16) * 0.05)(D, 3 * D)),
            "wo": _w((lambda *s: torch.randn(*s, dtype=torch.bfloat16) * 0.05)(D, D)),
        }
    _A_in = _A_setup()

    def _B_setup():
        B, S, D, F = 1, 2048, 512, 1376
        return {
            "x": _w((lambda *s: torch.randn(*s, dtype=torch.bfloat16) * 0.05)(B, S, D)),
            "w1": _w((lambda *s: torch.randn(*s, dtype=torch.bfloat16) * 0.4)(D, F) * (2.0 / D) ** 0.5),
            "w3": _w((lambda *s: torch.randn(*s, dtype=torch.bfloat16) * 0.4)(D, F) * (2.0 / D) ** 0.5),
            "w2": _w((lambda *s: torch.randn(*s, dtype=torch.bfloat16) * 0.4)(F, D) * (2.0 / F) ** 0.5),
        }
    _B_in = _B_setup()

    return {
        "A_x": _A_in["x"],
        "A_wqkv": _A_in["wqkv"],
        "A_wo": _A_in["wo"],
        "B_x": _B_in["x"],
        "B_w1": _B_in["w1"],
        "B_w3": _B_in["w3"],
        "B_w2": _B_in["w2"],
    }

def reference(A_x, A_wqkv, A_wo, B_x, B_w1, B_w3, B_w2):
    def _A_ref(x, wqkv, wo):
        B, S, D = x.shape
        H = 32; Dh = D // H
        qkv = (lambda x, *d: x.permute(*d))((x @ wqkv).reshape(B, S, 3, H, Dh), 2, 0, 3, 1, 4)
        q, k, v = qkv[0], qkv[1], qkv[2]
        scale = Dh ** -0.5
        scores = torch.einsum("bhqd,bhkd->bhqk", q, k) * scale
        p = _softmax(scores, axis=-1)
        o = torch.einsum("bhqk,bhkd->bhqd", p, v)
        return (lambda x, *d: x.permute(*d))(o, 0, 2, 1, 3).reshape(B, S, D) @ wo

    def _B_ref(x, w1, w3, w2):
        gate = torch.einsum("bsd,df->bsf", x, w1)
        up = torch.einsum("bsd,df->bsf", x, w3)
        h = _silu(gate) * up
        out = torch.einsum("bsf,fd->bsd", h, w2)
        return out

    x = A_x
    h = x + _A_ref(_layernorm(x, axis=-1), A_wqkv, A_wo)
    h2 = h + _B_ref(_layernorm(h, axis=-1), B_w1, B_w3, B_w2)
    return h2
```

```asm
; @launch grid=(256,1,1) block=(512,1,1) lds=163840
.amdgcn_target "amdgcn-amd-amdhsa--gfx950"
.text
.globl sequential_preLN__softmax_full_mha__glu_gated_swiglu__prompt_kernel
.p2align 8
.type sequential_preLN__softmax_full_mha__glu_gated_swiglu__prompt_kernel,@function
sequential_preLN__softmax_full_mha__glu_gated_swiglu__prompt_kernel:
    s_cmp_ge_u32 s2, 256
    s_cbranch_scc1 L_exit
    s_load_dwordx16 s[40:55], s[0:1], 0
    s_load_dwordx2 s[62:63], s[0:1], 72
    v_and_b32 v1, 63, v0
    v_lshrrev_b32 v2, 6, v0
    s_nop 0
    v_readfirstlane_b32 s3, v2
    v_lshlrev_b32 v2, 4, v1
    s_and_b32 s37, s2, 7
    s_lshr_b32 s38, s2, 3
    s_lshr_b32 s56, s38, 4
    s_lshl_b32 s57, s37, 1
    s_add_u32 s56, s56, s57
    s_and_b32 s57, s38, 15
    s_bfe_u32 s58, s38, 0x10003
    s_lshl_b32 s59, s56, 1
    s_add_u32 s58, s58, s59
    s_and_b32 s61, s38, 7
    s_mov_b32 s39, 0
    s_cmp_ge_u32 s3, 4
    s_cbranch_scc1 L_helper
    s_and_b32 s96, s3, 1
    s_lshr_b32 s97, s3, 1
    v_and_b32 v9, 31, v1
    v_lshrrev_b32 v10, 5, v1
    v_bfe_u32 v11, v1, 1, 3
    v_xor_b32 v11, v11, v10
    v_lshlrev_b32 v11, 4, v11
    v_lshl_add_u32 v11, v9, 7, v11
    s_lshl_b32 s98, s96, 12
    s_add_u32 s98, s98, 98304
    v_add_u32 v11, s98, v11
    v_xor_b32 v4, 0, v11
    v_xor_b32 v5, 32, v11
    v_xor_b32 v6, 64, v11
    v_xor_b32 v7, 96, v11
    v_lshrrev_b32 v8, 5, v1
    v_mul_u32_u24 v8, 3072, v8
    v_bfe_u32 v11, v1, 2, 2
    v_lshl_add_u32 v8, v11, 7, v8
    v_bfe_u32 v11, v1, 3, 1
    v_xor_b32 v11, s97, v11
    v_lshl_add_u32 v8, v11, 6, v8
    v_bfe_u32 v11, v1, 4, 1
    v_lshl_add_u32 v8, v11, 5, v8
    v_and_b32 v11, 1, v1
    v_lshl_add_u32 v8, v11, 4, v8
    v_bfe_u32 v11, v1, 1, 1
    v_lshl_add_u32 v8, v11, 3, v8
    v_add_u32 v3, 49152, v8
    v_mov_b32 v16, 0
    v_mov_b32 v17, 0
    s_lshl_b32 s98, s3, 9
    s_add_u32 s98, s98, 159744
    v_lshl_add_u32 v11, v1, 3, s98
    ds_write_b64 v11, v[16:17]
    s_waitcnt lgkmcnt(0)
    s_load_dword s36, s[62:63], 0
    s_mov_b32 s4, s40
    s_mov_b32 s5, s41
    s_mov_b32 s6, 0x200000
    s_mov_b32 s7, 0x00020000
    s_mov_b32 s8, s42
    s_mov_b32 s9, s43
    s_mov_b32 s10, 0x180000
    s_mov_b32 s11, 0x00020000
    s_mov_b32 s12, s62
    s_mov_b32 s13, s63
    s_mov_b32 s14, 0x1800000
    s_mov_b32 s15, 0x00020000
    s_mov_b32 s16, s44
    s_mov_b32 s17, s45
    s_mov_b32 s18, 0x80000
    s_mov_b32 s19, 0x00020000
    s_mov_b32 s20, s48
    s_mov_b32 s21, s49
    s_mov_b32 s22, 0x158000
    s_mov_b32 s23, 0x00020000
    s_mov_b32 s24, s50
    s_mov_b32 s25, s51
    s_mov_b32 s26, 0x158000
    s_mov_b32 s27, 0x00020000
    s_mov_b32 s28, s52
    s_mov_b32 s29, s53
    s_mov_b32 s30, 0x158000
    s_mov_b32 s31, 0x00020000
    s_mov_b32 s32, s54
    s_mov_b32 s33, s55
    s_mov_b32 s34, 0x200000
    s_mov_b32 s35, 0x00020000
    v_lshrrev_b32 v11, 2, v1
    v_xor_b32 v11, v11, v1
    v_bfe_u32 v11, v11, 2, 1
    v_add_u32 v11, -1, v11
    v_and_b32 v192, 0x3f803f80, v11
    v_and_b32 v193, 0x3f803f80, v11
    v_and_b32 v194, 0x3f803f80, v11
    v_and_b32 v195, 0x3f803f80, v11
    v_lshlrev_b32 v13, 2, v9
    v_lshlrev_b32 v12, 3, v9
    v_lshl_add_u32 v239, v10, 10, v12
    s_add_u32 s98, s38, 6
    s_add_u32 s99, s38, 3
    s_and_b32 s98, s98, 7
    s_and_b32 s99, s99, 7
    s_lshl_b32 s98, s98, 12
    s_lshl_b32 s99, s99, 12
    s_add_u32 s98, s98, 1024
    s_sub_u32 s99, s99, s98
    v_mul_lo_u32 v11, v10, s99
    v_add3_u32 v12, v12, v11, s98
    v_mov_b32 v208, 0
    v_mov_b32 v209, 0
    v_mov_b32 v210, 0
    s_lshl_b32 s98, s96, 7
    s_add_u32 s98, s98, 163328
    v_add_u32 v14, s98, v13
    v_lshl_add_u32 v15, v10, 4, s98
    v_mov_b32 v126, 0
    v_mov_b32 v127, 0
    s_lshl_b32 s44, s38, 1
    s_add_u32 s44, s44, s96
    s_lshl_b32 s47, s37, 1
    s_add_u32 s47, s47, s97
    s_lshl_b32 s46, s37, 7
    s_add_u32 s46, s46, 4096
    s_lshl_b32 s45, s38, 2
    s_add_u32 s45, s45, s46
    s_lshl_b32 s98, s37, 5
    s_add_u32 s98, s98, s38
    s_and_b32 s99, s98, 0xfffffff8
    s_lshl_b32 s98, s98, 1
    s_lshl_b32 s99, s99, 1
    s_add_u32 s98, s98, s97
    s_add_u32 s99, s99, s97
    s_lshl_b32 s98, s98, 11
    s_lshl_b32 s99, s99, 11
    s_add_u32 s98, s98, 3145728
    s_add_u32 s99, s99, 3145728
    s_waitcnt lgkmcnt(0)
    s_add_u32 s63, s36, 1
    s_mul_i32 s36, s63, 0x9E3779B1
    s_getreg_b32 s40, hwreg(HW_REG_XCC_ID)
    s_lshl_b32 s40, s40, 28
    s_and_b32 s42, s36, 0x0fffffff
    s_or_b32 s40, s40, s42
    v_mov_b32 v101, s40
    v_mov_b32 v221, s36
    v_mov_b32 v223, s36
    v_mov_b32 v225, s36
    v_mov_b32 v114, 0
    v_mov_b32 v115, 0
    v_mov_b32 v118, 0
    v_mov_b32 v119, 0
    v_mov_b32 v122, 0
    v_mov_b32 v123, 0
    v_and_b32 v236, 0x33, v1
    v_bfe_u32 v237, v1, 2, 1
    v_lshl_add_u32 v236, v237, 3, v236
    v_bfe_u32 v237, v1, 3, 1
    v_lshl_add_u32 v236, v237, 2, v236
    v_lshlrev_b32 v236, 4, v236
    v_and_b32 v237, 15, v1
    v_lshlrev_b32 v237, 4, v237
    v_lshl_add_u32 v237, v10, 8, v237
    v_bfe_u32 v238, v1, 4, 1
    v_lshl_add_u32 v237, v238, 17, v237
    s_lshl_b32 s50, s47, 7
    s_add_u32 s50, s50, s44
    s_lshl_b32 s51, s50, 11
    s_lshl_b32 s50, s50, 10
    s_add_u32 s50, s50, 1048576
    s_add_u32 s51, s51, 4194304
    s_add_u32 s52, s50, 65536
    s_add_u32 s53, s51, 131072
    s_lshl_b32 s101, s47, 8
    s_lshl_b32 s44, s44, 2
    s_add_u32 s101, s101, s44
    s_add_u32 s101, s101, 8192
    s_cmp_eq_u32 s3, 0
    s_cselect_b64 s[54:55], 1, 0
    s_cmp_eq_u32 s96, 1
    s_cselect_b64 s[48:49], -1, 0
    v_and_b32 v248, 15, v1
    v_lshlrev_b32 v248, 7, v248
    v_bfe_u32 v250, v1, 4, 1
    v_lshl_add_u32 v248, v250, 17, v248
    v_and_b32 v249, 7, v1
    v_lshlrev_b32 v249, 7, v249
    v_bfe_u32 v250, v1, 3, 1
    v_lshl_add_u32 v249, v250, 16, v249
    s_barrier
    ds_read_b128 v[144:147], v4 offset:0
    ds_read_b64_tr_b16 v[156:157], v8 offset:0
    ds_read_b64_tr_b16 v[158:159], v8 offset:512
    ds_read_b64_tr_b16 v[160:161], v8 offset:1024
    ds_read_b64_tr_b16 v[162:163], v8 offset:1536
    ds_read_b64_tr_b16 v[164:165], v8 offset:2048
    ds_read_b64_tr_b16 v[166:167], v8 offset:2560
    ds_read_b128 v[148:151], v5 offset:0
    ds_read_b64_tr_b16 v[168:169], v8 offset:6144
    ds_read_b64_tr_b16 v[170:171], v8 offset:6656
    ds_read_b64_tr_b16 v[172:173], v8 offset:7168
    ds_read_b64_tr_b16 v[174:175], v8 offset:7680
    ds_read_b64_tr_b16 v[176:177], v8 offset:8192
    ds_read_b64_tr_b16 v[178:179], v8 offset:8704
    ds_read_b128 v[152:155], v6 offset:0
    ds_read_b64_tr_b16 v[180:181], v8 offset:12288
    ds_read_b64_tr_b16 v[182:183], v8 offset:12800
    s_waitcnt lgkmcnt(14)
    v_mfma_f32_32x32x16_bf16 v[16:31], v[156:159], v[144:147], 0
    v_mfma_f32_16x16x32_bf16 v[196:199], v[192:195], v[156:159], 0
    ds_read_b64_tr_b16 v[184:185], v8 offset:13312
    ds_read_b64_tr_b16 v[186:187], v8 offset:13824
    s_waitcnt lgkmcnt(14)
    v_mfma_f32_32x32x16_bf16 v[32:47], v[160:163], v[144:147], 0
    v_mfma_f32_16x16x32_bf16 v[200:203], v[192:195], v[160:163], 0
    ds_read_b64_tr_b16 v[188:189], v8 offset:14336
    ds_read_b64_tr_b16 v[190:191], v8 offset:14848
    s_waitcnt lgkmcnt(14)
    v_mfma_f32_32x32x16_bf16 v[48:63], v[144:147], v[164:167], 0
    v_mfma_f32_16x16x32_bf16 v[204:207], v[192:195], v[164:167], 0
    ds_read_b128 v[144:147], v7 offset:0
    ds_read_b64_tr_b16 v[156:157], v8 offset:18432
    ds_read_b64_tr_b16 v[158:159], v8 offset:18944
    s_waitcnt lgkmcnt(14)
    v_mfma_f32_32x32x16_bf16 v[16:31], v[168:171], v[148:151], v[16:31]
    v_mfma_f32_16x16x32_bf16 v[196:199], v[192:195], v[168:171], v[196:199]
    ds_read_b64_tr_b16 v[160:161], v8 offset:19456
    ds_read_b64_tr_b16 v[162:163], v8 offset:19968
    s_waitcnt lgkmcnt(14)
    v_mfma_f32_32x32x16_bf16 v[32:47], v[172:175], v[148:151], v[32:47]
    v_mfma_f32_16x16x32_bf16 v[200:203], v[192:195], v[172:175], v[200:203]
    ds_read_b64_tr_b16 v[164:165], v8 offset:20480
    ds_read_b64_tr_b16 v[166:167], v8 offset:20992
    s_waitcnt lgkmcnt(14)
    v_mfma_f32_32x32x16_bf16 v[48:63], v[148:151], v[176:179], v[48:63]
    v_mfma_f32_16x16x32_bf16 v[204:207], v[192:195], v[176:179], v[204:207]
    s_barrier
    ds_read_b128 v[148:151], v4 offset:8192
    ds_read_b64_tr_b16 v[168:169], v8 offset:24576
    ds_read_b64_tr_b16 v[170:171], v8 offset:25088
    s_waitcnt lgkmcnt(14)
    v_mfma_f32_32x32x16_bf16 v[16:31], v[180:183], v[152:155], v[16:31]
    v_mfma_f32_16x16x32_bf16 v[196:199], v[192:195], v[180:183], v[196:199]
    ds_read_b64_tr_b16 v[172:173], v8 offset:25600
    ds_read_b64_tr_b16 v[174:175], v8 offset:26112
    s_waitcnt lgkmcnt(14)
    v_mfma_f32_32x32x16_bf16 v[32:47], v[184:187], v[152:155], v[32:47]
    v_mfma_f32_16x16x32_bf16 v[200:203], v[192:195], v[184:187], v[200:203]
    ds_read_b64_tr_b16 v[176:177], v8 offset:26624
    ds_read_b64_tr_b16 v[178:179], v8 offset:27136
    s_waitcnt lgkmcnt(14)
    v_mfma_f32_32x32x16_bf16 v[48:63], v[152:155], v[188:191], v[48:63]
    v_mfma_f32_16x16x32_bf16 v[204:207], v[192:195], v[188:191], v[204:207]
    ds_read_b128 v[152:155], v5 offset:8192
    ds_read_b64_tr_b16 v[180:181], v8 offset:30720
    ds_read_b64_tr_b16 v[182:183], v8 offset:31232
    s_waitcnt lgkmcnt(14)
    v_mfma_f32_32x32x16_bf16 v[16:31], v[156:159], v[144:147], v[16:31]
    v_mfma_f32_16x16x32_bf16 v[196:199], v[192:195], v[156:159], v[196:199]
    ds_read_b64_tr_b16 v[184:185], v8 offset:31744
    ds_read_b64_tr_b16 v[186:187], v8 offset:32256
    s_waitcnt lgkmcnt(14)
    v_mfma_f32_32x32x16_bf16 v[32:47], v[160:163], v[144:147], v[32:47]
    v_mfma_f32_16x16x32_bf16 v[200:203], v[192:195], v[160:163], v[200:203]
    ds_read_b64_tr_b16 v[188:189], v8 offset:32768
    ds_read_b64_tr_b16 v[190:191], v8 offset:33280
    s_waitcnt lgkmcnt(14)
    v_mfma_f32_32x32x16_bf16 v[48:63], v[144:147], v[164:167], v[48:63]
    v_mfma_f32_16x16x32_bf16 v[204:207], v[192:195], v[164:167], v[204:207]
    ds_read_b128 v[144:147], v6 offset:8192
    ds_read_b64_tr_b16 v[156:157], v8 offset:36864
    ds_read_b64_tr_b16 v[158:159], v8 offset:37376
    s_waitcnt lgkmcnt(14)
    v_mfma_f32_32x32x16_bf16 v[16:31], v[168:171], v[148:151], v[16:31]
    v_mfma_f32_16x16x32_bf16 v[196:199], v[192:195], v[168:171], v[196:199]
    ds_read_b64_tr_b16 v[160:161], v8 offset:37888
    ds_read_b64_tr_b16 v[162:163], v8 offset:38400
    s_waitcnt lgkmcnt(14)
    v_mfma_f32_32x32x16_bf16 v[32:47], v[172:175], v[148:151], v[32:47]
    v_mfma_f32_16x16x32_bf16 v[200:203], v[192:195], v[172:175], v[200:203]
    s_cmp_lt_u32 s38, 4
    s_cselect_b32 s95, s51, 1073741824
    s_mov_b64 exec, 0xffffffff
    buffer_load_dword v250, v248, s[12:15], s95 offen sc1
    s_mov_b64 exec, 0xffff
    buffer_load_dword v251, v249, s[12:15], s50 offen sc1
    s_mov_b64 exec, -1
    ds_read_b64_tr_b16 v[164:165], v8 offset:38912
    ds_read_b64_tr_b16 v[166:167], v8 offset:39424
    s_waitcnt lgkmcnt(14)
    v_mfma_f32_32x32x16_bf16 v[48:63], v[148:151], v[176:179], v[48:63]
    v_mfma_f32_16x16x32_bf16 v[204:207], v[192:195], v[176:179], v[204:207]
    ds_read_b128 v[148:151], v7 offset:8192
    ds_read_b64_tr_b16 v[168:169], v8 offset:43008
    ds_read_b64_tr_b16 v[170:171], v8 offset:43520
    s_waitcnt lgkmcnt(14)
    v_mfma_f32_32x32x16_bf16 v[16:31], v[180:183], v[152:155], v[16:31]
    v_mfma_f32_16x16x32_bf16 v[196:199], v[192:195], v[180:183], v[196:199]
    s_mov_b64 exec, s[54:55]
    buffer_store_dword v101, off, s[12:15], s45 sc1
    s_mov_b64 exec, -1
    ds_read_b64_tr_b16 v[172:173], v8 offset:44032
    ds_read_b64_tr_b16 v[174:175], v8 offset:44544
    s_waitcnt lgkmcnt(14)
    v_mfma_f32_32x32x16_bf16 v[32:47], v[184:187], v[152:155], v[32:47]
    v_mfma_f32_16x16x32_bf16 v[200:203], v[192:195], v[184:187], v[200:203]
    ds_read_b64_tr_b16 v[176:177], v8 offset:45056
    ds_read_b64_tr_b16 v[178:179], v8 offset:45568
    s_waitcnt lgkmcnt(14)
    v_mfma_f32_32x32x16_bf16 v[48:63], v[152:155], v[188:191], v[48:63]
    v_mfma_f32_16x16x32_bf16 v[204:207], v[192:195], v[188:191], v[204:207]
    s_barrier
    ds_read_b128 v[152:155], v4 offset:16384
    ds_read_b64_tr_b16 v[180:181], v3 offset:0
    ds_read_b64_tr_b16 v[182:183], v3 offset:512
    s_waitcnt lgkmcnt(14)
    v_mfma_f32_32x32x16_bf16 v[16:31], v[156:159], v[144:147], v[16:31]
    v_mfma_f32_16x16x32_bf16 v[196:199], v[192:195], v[156:159], v[196:199]
    ds_read_b64_tr_b16 v[184:185], v3 offset:1024
    ds_read_b64_tr_b16 v[186:187], v3 offset:1536
    s_waitcnt lgkmcnt(14)
    v_mfma_f32_32x32x16_bf16 v[32:47], v[160:163], v[144:147], v[32:47]
    v_mfma_f32_16x16x32_bf16 v[200:203], v[192:195], v[160:163], v[200:203]
    ds_read_b64_tr_b16 v[188:189], v3 offset:2048
    ds_read_b64_tr_b16 v[190:191], v3 offset:2560
    s_waitcnt lgkmcnt(14)
    v_mfma_f32_32x32x16_bf16 v[48:63], v[144:147], v[164:167], v[48:63]
    v_mfma_f32_16x16x32_bf16 v[204:207], v[192:195], v[164:167], v[204:207]
    ds_read_b128 v[144:147], v5 offset:16384
    ds_read_b64_tr_b16 v[156:157], v3 offset:6144
    ds_read_b64_tr_b16 v[158:159], v3 offset:6656
    s_waitcnt lgkmcnt(14)
    v_mfma_f32_32x32x16_bf16 v[16:31], v[168:171], v[148:151], v[16:31]
    v_mfma_f32_16x16x32_bf16 v[196:199], v[192:195], v[168:171], v[196:199]
    ds_read_b64_tr_b16 v[160:161], v3 offset:7168
    ds_read_b64_tr_b16 v[162:163], v3 offset:7680
    s_waitcnt lgkmcnt(14)
    v_mfma_f32_32x32x16_bf16 v[32:47], v[172:175], v[148:151], v[32:47]
    v_mfma_f32_16x16x32_bf16 v[200:203], v[192:195], v[172:175], v[200:203]
    ds_read_b64_tr_b16 v[164:165], v3 offset:8192
    ds_read_b64_tr_b16 v[166:167], v3 offset:8704
    s_waitcnt lgkmcnt(14)
    v_mfma_f32_32x32x16_bf16 v[48:63], v[148:151], v[176:179], v[48:63]
    v_mfma_f32_16x16x32_bf16 v[204:207], v[192:195], v[176:179], v[204:207]
    ds_read_b128 v[148:151], v6 offset:16384
    ds_read_b64_tr_b16 v[168:169], v3 offset:12288
    ds_read_b64_tr_b16 v[170:171], v3 offset:12800
    s_waitcnt lgkmcnt(14)
    v_mfma_f32_32x32x16_bf16 v[16:31], v[180:183], v[152:155], v[16:31]
    v_mov_b32 v220, v196
    v_mfma_f32_16x16x32_bf16 v[196:199], v[192:195], v[180:183], v[196:199]
    ds_read_b64_tr_b16 v[172:173], v3 offset:13312
    ds_read_b64_tr_b16 v[174:175], v3 offset:13824
    s_waitcnt lgkmcnt(14)
    v_mfma_f32_32x32x16_bf16 v[32:47], v[184:187], v[152:155], v[32:47]
    v_mov_b32 v222, v200
    v_mfma_f32_16x16x32_bf16 v[200:203], v[192:195], v[184:187], v[200:203]
    ds_read_b64_tr_b16 v[176:177], v3 offset:14336
    ds_read_b64_tr_b16 v[178:179], v3 offset:14848
    s_waitcnt lgkmcnt(14)
    v_mfma_f32_32x32x16_bf16 v[48:63], v[152:155], v[188:191], v[48:63]
    v_mov_b32 v224, v204
    v_mfma_f32_16x16x32_bf16 v[204:207], v[192:195], v[188:191], v[204:207]
    ds_read_b128 v[152:155], v7 offset:16384
    ds_read_b64_tr_b16 v[180:181], v3 offset:18432
    ds_read_b64_tr_b16 v[182:183], v3 offset:18944
    s_waitcnt lgkmcnt(14)
    v_mfma_f32_32x32x16_bf16 v[16:31], v[156:159], v[144:147], v[16:31]
    v_mfma_f32_16x16x32_bf16 v[196:199], v[192:195], v[156:159], v[196:199]
    ds_read_b64_tr_b16 v[184:185], v3 offset:19456
    ds_read_b64_tr_b16 v[186:187], v3 offset:19968
    s_waitcnt lgkmcnt(14)
    v_mfma_f32_32x32x16_bf16 v[32:47], v[160:163], v[144:147], v[32:47]
    v_mfma_f32_16x16x32_bf16 v[200:203], v[192:195], v[160:163], v[200:203]
    ds_read_b64_tr_b16 v[188:189], v3 offset:20480
    ds_read_b64_tr_b16 v[190:191], v3 offset:20992
    s_waitcnt lgkmcnt(14)
    v_mfma_f32_32x32x16_bf16 v[48:63], v[144:147], v[164:167], v[48:63]
    v_mfma_f32_16x16x32_bf16 v[204:207], v[192:195], v[164:167], v[204:207]
    s_barrier
    ds_read_b128 v[144:147], v4 offset:24576
    ds_read_b64_tr_b16 v[156:157], v3 offset:24576
    ds_read_b64_tr_b16 v[158:159], v3 offset:25088
    s_waitcnt lgkmcnt(14)
    v_mfma_f32_32x32x16_bf16 v[16:31], v[168:171], v[148:151], v[16:31]
    v_mfma_f32_16x16x32_bf16 v[196:199], v[192:195], v[168:171], v[196:199]
    ds_read_b64_tr_b16 v[160:161], v3 offset:25600
    ds_read_b64_tr_b16 v[162:163], v3 offset:26112
    s_waitcnt lgkmcnt(14)
    v_mfma_f32_32x32x16_bf16 v[32:47], v[172:175], v[148:151], v[32:47]
    v_mfma_f32_16x16x32_bf16 v[200:203], v[192:195], v[172:175], v[200:203]
    ds_read_b64_tr_b16 v[164:165], v3 offset:26624
    ds_read_b64_tr_b16 v[166:167], v3 offset:27136
    s_waitcnt lgkmcnt(14)
    v_mfma_f32_32x32x16_bf16 v[48:63], v[148:151], v[176:179], v[48:63]
    v_mfma_f32_16x16x32_bf16 v[204:207], v[192:195], v[176:179], v[204:207]
    ds_read_b128 v[148:151], v5 offset:24576
    ds_read_b64_tr_b16 v[168:169], v3 offset:30720
    ds_read_b64_tr_b16 v[170:171], v3 offset:31232
    s_waitcnt lgkmcnt(14)
    v_mfma_f32_32x32x16_bf16 v[16:31], v[180:183], v[152:155], v[16:31]
    v_mfma_f32_16x16x32_bf16 v[196:199], v[192:195], v[180:183], v[196:199]
    ds_read_b64_tr_b16 v[172:173], v3 offset:31744
    ds_read_b64_tr_b16 v[174:175], v3 offset:32256
    s_waitcnt lgkmcnt(14)
    v_mfma_f32_32x32x16_bf16 v[32:47], v[184:187], v[152:155], v[32:47]
    v_mfma_f32_16x16x32_bf16 v[200:203], v[192:195], v[184:187], v[200:203]
    ds_read_b64_tr_b16 v[176:177], v3 offset:32768
    ds_read_b64_tr_b16 v[178:179], v3 offset:33280
    s_waitcnt lgkmcnt(14)
    v_mfma_f32_32x32x16_bf16 v[48:63], v[152:155], v[188:191], v[48:63]
    v_mfma_f32_16x16x32_bf16 v[204:207], v[192:195], v[188:191], v[204:207]
    ds_read_b128 v[152:155], v6 offset:24576
    ds_read_b64_tr_b16 v[180:181], v3 offset:36864
    ds_read_b64_tr_b16 v[182:183], v3 offset:37376
    s_waitcnt lgkmcnt(14)
    v_mfma_f32_32x32x16_bf16 v[16:31], v[156:159], v[144:147], v[16:31]
    s_mov_b64 exec, 0xffffffff
    v_mov_b32 v220, v196
    v_mov_b32 v208, v196
    s_mov_b64 exec, s[48:49]
    buffer_store_dwordx2 v[220:221], v239, s[12:15], s98 offen offset:0 sc1
    s_mov_b64 exec, -1
    ds_read_b64_tr_b16 v[184:185], v3 offset:37888
    ds_read_b64_tr_b16 v[186:187], v3 offset:38400
    s_waitcnt lgkmcnt(14)
    v_mfma_f32_32x32x16_bf16 v[32:47], v[160:163], v[144:147], v[32:47]
    s_mov_b64 exec, 0xffffffff
    v_mov_b32 v222, v200
    v_mov_b32 v209, v200
    s_mov_b64 exec, s[48:49]
    buffer_store_dwordx2 v[222:223], v239, s[12:15], s98 offen offset:256 sc1
    s_mov_b64 exec, -1
    ds_read_b64_tr_b16 v[188:189], v3 offset:38912
    ds_read_b64_tr_b16 v[190:191], v3 offset:39424
    s_waitcnt lgkmcnt(14)
    v_mfma_f32_32x32x16_bf16 v[48:63], v[144:147], v[164:167], v[48:63]
    s_mov_b64 exec, 0xffffffff
    v_mov_b32 v224, v204
    v_mov_b32 v210, v204
    s_mov_b64 exec, s[48:49]
    buffer_store_dwordx2 v[224:225], v239, s[12:15], s98 offen offset:512 sc1
    s_mov_b64 exec, -1
    ds_read_b128 v[144:147], v7 offset:24576
    ds_read_b64_tr_b16 v[156:157], v3 offset:43008
    ds_read_b64_tr_b16 v[158:159], v3 offset:43520
    s_waitcnt lgkmcnt(14)
    v_mfma_f32_32x32x16_bf16 v[16:31], v[168:171], v[148:151], v[16:31]
    ds_read_b64_tr_b16 v[160:161], v3 offset:44032
    ds_read_b64_tr_b16 v[162:163], v3 offset:44544
    s_waitcnt lgkmcnt(14)
    v_mfma_f32_32x32x16_bf16 v[32:47], v[172:175], v[148:151], v[32:47]
    ds_read_b64_tr_b16 v[164:165], v3 offset:45056
    ds_read_b64_tr_b16 v[166:167], v3 offset:45568
    s_waitcnt lgkmcnt(14)
    v_mfma_f32_32x32x16_bf16 v[48:63], v[148:151], v[176:179], v[48:63]
    s_barrier
    ds_read_b128 v[148:151], v4 offset:32768
    ds_read_b64_tr_b16 v[168:169], v8 offset:0
    ds_read_b64_tr_b16 v[170:171], v8 offset:512
    s_waitcnt lgkmcnt(14)
    v_mfma_f32_32x32x16_bf16 v[16:31], v[180:183], v[152:155], v[16:31]
    ds_read_b64_tr_b16 v[172:173], v8 offset:1024
    ds_read_b64_tr_b16 v[174:175], v8 offset:1536
    s_waitcnt lgkmcnt(14)
    v_mfma_f32_32x32x16_bf16 v[32:47], v[184:187], v[152:155], v[32:47]
    ds_read_b64_tr_b16 v[176:177], v8 offset:2048
    ds_read_b64_tr_b16 v[178:179], v8 offset:2560
    s_waitcnt lgkmcnt(14)
    v_mfma_f32_32x32x16_bf16 v[48:63], v[152:155], v[188:191], v[48:63]
    ds_read_b128 v[152:155], v5 offset:32768
    ds_read_b64_tr_b16 v[180:181], v8 offset:6144
    ds_read_b64_tr_b16 v[182:183], v8 offset:6656
    s_waitcnt lgkmcnt(14)
    v_mfma_f32_32x32x16_bf16 v[16:31], v[156:159], v[144:147], v[16:31]
    ds_read_b64_tr_b16 v[184:185], v8 offset:7168
    ds_read_b64_tr_b16 v[186:187], v8 offset:7680
    s_waitcnt lgkmcnt(14)
    v_mfma_f32_32x32x16_bf16 v[32:47], v[160:163], v[144:147], v[32:47]
    ds_read_b64_tr_b16 v[188:189], v8 offset:8192
    ds_read_b64_tr_b16 v[190:191], v8 offset:8704
    s_waitcnt lgkmcnt(14)
    v_mfma_f32_32x32x16_bf16 v[48:63], v[144:147], v[164:167], v[48:63]
    ds_read_b128 v[144:147], v6 offset:32768
    ds_read_b64_tr_b16 v[156:157], v8 offset:12288
    ds_read_b64_tr_b16 v[158:159], v8 offset:12800
    s_waitcnt lgkmcnt(14)
    v_mfma_f32_32x32x16_bf16 v[16:31], v[168:171], v[148:151], v[16:31]
    ds_read_b64_tr_b16 v[160:161], v8 offset:13312
    ds_read_b64_tr_b16 v[162:163], v8 offset:13824
    s_waitcnt lgkmcnt(14)
    v_mfma_f32_32x32x16_bf16 v[32:47], v[172:175], v[148:151], v[32:47]
    ds_read_b64_tr_b16 v[164:165], v8 offset:14336
    ds_read_b64_tr_b16 v[166:167], v8 offset:14848
    s_waitcnt lgkmcnt(14)
    v_mfma_f32_32x32x16_bf16 v[48:63], v[148:151], v[176:179], v[48:63]
    ds_read_b128 v[148:151], v7 offset:32768
    ds_read_b64_tr_b16 v[168:169], v8 offset:18432
    ds_read_b64_tr_b16 v[170:171], v8 offset:18944
    s_waitcnt lgkmcnt(14)
    v_mfma_f32_32x32x16_bf16 v[16:31], v[180:183], v[152:155], v[16:31]
    ds_read_b64_tr_b16 v[172:173], v8 offset:19456
    ds_read_b64_tr_b16 v[174:175], v8 offset:19968
    s_waitcnt lgkmcnt(14)
    v_mfma_f32_32x32x16_bf16 v[32:47], v[184:187], v[152:155], v[32:47]
    ds_read_b64_tr_b16 v[176:177], v8 offset:20480
    ds_read_b64_tr_b16 v[178:179], v8 offset:20992
    s_waitcnt lgkmcnt(14)
    v_mfma_f32_32x32x16_bf16 v[48:63], v[152:155], v[188:191], v[48:63]
    s_barrier
    ds_read_b128 v[152:155], v4 offset:0
    ds_read_b64_tr_b16 v[180:181], v8 offset:24576
    ds_read_b64_tr_b16 v[182:183], v8 offset:25088
    s_waitcnt lgkmcnt(14)
    v_mfma_f32_32x32x16_bf16 v[16:31], v[156:159], v[144:147], v[16:31]
    ds_read_b64_tr_b16 v[184:185], v8 offset:25600
    ds_read_b64_tr_b16 v[186:187], v8 offset:26112
    s_waitcnt lgkmcnt(14)
    v_mfma_f32_32x32x16_bf16 v[32:47], v[160:163], v[144:147], v[32:47]
    ds_read_b64_tr_b16 v[188:189], v8 offset:26624
    ds_read_b64_tr_b16 v[190:191], v8 offset:27136
    s_waitcnt lgkmcnt(14)
    v_mfma_f32_32x32x16_bf16 v[48:63], v[144:147], v[164:167], v[48:63]
    ds_read_b128 v[144:147], v5 offset:0
    ds_read_b64_tr_b16 v[156:157], v8 offset:30720
    ds_read_b64_tr_b16 v[158:159], v8 offset:31232
    s_waitcnt lgkmcnt(14)
    v_mfma_f32_32x32x16_bf16 v[16:31], v[168:171], v[148:151], v[16:31]
    ds_read_b64_tr_b16 v[160:161], v8 offset:31744
    ds_read_b64_tr_b16 v[162:163], v8 offset:32256
    s_waitcnt lgkmcnt(14)
    v_mfma_f32_32x32x16_bf16 v[32:47], v[172:175], v[148:151], v[32:47]
    ds_read_b64_tr_b16 v[164:165], v8 offset:32768
    ds_read_b64_tr_b16 v[166:167], v8 offset:33280
    s_waitcnt lgkmcnt(14)
    v_mfma_f32_32x32x16_bf16 v[48:63], v[148:151], v[176:179], v[48:63]
    ds_read_b128 v[148:151], v6 offset:0
    ds_read_b64_tr_b16 v[168:169], v8 offset:36864
    ds_read_b64_tr_b16 v[170:171], v8 offset:37376
    s_waitcnt lgkmcnt(14)
    v_mfma_f32_32x32x16_bf16 v[16:31], v[180:183], v[152:155], v[16:31]
    ds_read_b64_tr_b16 v[172:173], v8 offset:37888
    ds_read_b64_tr_b16 v[174:175], v8 offset:38400
    s_waitcnt lgkmcnt(14)
    v_mfma_f32_32x32x16_bf16 v[32:47], v[184:187], v[152:155], v[32:47]
    ds_read_b64_tr_b16 v[176:177], v8 offset:38912
    ds_read_b64_tr_b16 v[178:179], v8 offset:39424
    s_waitcnt lgkmcnt(14)
    v_mfma_f32_32x32x16_bf16 v[48:63], v[152:155], v[188:191], v[48:63]
    ds_read_b128 v[152:155], v7 offset:0
    ds_read_b64_tr_b16 v[180:181], v8 offset:43008
    ds_read_b64_tr_b16 v[182:183], v8 offset:43520
    s_waitcnt lgkmcnt(14)
    v_mfma_f32_32x32x16_bf16 v[16:31], v[156:159], v[144:147], v[16:31]
    ds_read_b64_tr_b16 v[184:185], v8 offset:44032
    ds_read_b64_tr_b16 v[186:187], v8 offset:44544
    s_waitcnt lgkmcnt(14)
    v_mfma_f32_32x32x16_bf16 v[32:47], v[160:163], v[144:147], v[32:47]
    ds_read_b64_tr_b16 v[188:189], v8 offset:45056
    ds_read_b64_tr_b16 v[190:191], v8 offset:45568
    s_waitcnt lgkmcnt(14)
    v_mfma_f32_32x32x16_bf16 v[48:63], v[144:147], v[164:167], v[48:63]
    buffer_load_dword v100, v13, s[12:15], s46 offen sc1
    s_barrier
    ds_read_b128 v[144:147], v4 offset:8192
    ds_read_b64_tr_b16 v[156:157], v3 offset:0
    ds_read_b64_tr_b16 v[158:159], v3 offset:512
    s_waitcnt lgkmcnt(14)
    v_mfma_f32_32x32x16_bf16 v[16:31], v[168:171], v[148:151], v[16:31]
    buffer_load_dwordx2 v[212:213], v12, s[12:15], s99 offen offset:0 sc1
    ds_read_b64_tr_b16 v[160:161], v3 offset:1024
    ds_read_b64_tr_b16 v[162:163], v3 offset:1536
    s_waitcnt lgkmcnt(14)
    v_mfma_f32_32x32x16_bf16 v[32:47], v[172:175], v[148:151], v[32:47]
    buffer_load_dwordx2 v[214:215], v12, s[12:15], s99 offen offset:256 sc1
    ds_read_b64_tr_b16 v[164:165], v3 offset:2048
    ds_read_b64_tr_b16 v[166:167], v3 offset:2560
    s_waitcnt lgkmcnt(14)
    v_mfma_f32_32x32x16_bf16 v[48:63], v[148:151], v[176:179], v[48:63]
    buffer_load_dwordx2 v[216:217], v12, s[12:15], s99 offen offset:512 sc1
    ds_read_b128 v[148:151], v5 offset:8192
    ds_read_b64_tr_b16 v[168:169], v3 offset:6144
    ds_read_b64_tr_b16 v[170:171], v3 offset:6656
    s_waitcnt lgkmcnt(14)
    v_mfma_f32_32x32x16_bf16 v[16:31], v[180:183], v[152:155], v[16:31]
    ds_read_b64_tr_b16 v[172:173], v3 offset:7168
    ds_read_b64_tr_b16 v[174:175], v3 offset:7680
    s_waitcnt lgkmcnt(14)
    v_mfma_f32_32x32x16_bf16 v[32:47], v[184:187], v[152:155], v[32:47]
    ds_read_b64_tr_b16 v[176:177], v3 offset:8192
    ds_read_b64_tr_b16 v[178:179], v3 offset:8704
    s_waitcnt lgkmcnt(14)
    v_mfma_f32_32x32x16_bf16 v[48:63], v[152:155], v[188:191], v[48:63]
    ds_read_b128 v[152:155], v6 offset:8192
    ds_read_b64_tr_b16 v[180:181], v3 offset:12288
    ds_read_b64_tr_b16 v[182:183], v3 offset:12800
    s_waitcnt lgkmcnt(14)
    v_mfma_f32_32x32x16_bf16 v[16:31], v[156:159], v[144:147], v[16:31]
    ds_read_b64_tr_b16 v[184:185], v3 offset:13312
    ds_read_b64_tr_b16 v[186:187], v3 offset:13824
    s_waitcnt lgkmcnt(14)
    v_mfma_f32_32x32x16_bf16 v[32:47], v[160:163], v[144:147], v[32:47]
    ds_read_b64_tr_b16 v[188:189], v3 offset:14336
    ds_read_b64_tr_b16 v[190:191], v3 offset:14848
    s_waitcnt lgkmcnt(14)
    v_mfma_f32_32x32x16_bf16 v[48:63], v[144:147], v[164:167], v[48:63]
    ds_read_b128 v[144:147], v7 offset:8192
    ds_read_b64_tr_b16 v[156:157], v3 offset:18432
    ds_read_b64_tr_b16 v[158:159], v3 offset:18944
    s_waitcnt lgkmcnt(14)
    v_mfma_f32_32x32x16_bf16 v[16:31], v[168:171], v[148:151], v[16:31]
    ds_read_b64_tr_b16 v[160:161], v3 offset:19456
    ds_read_b64_tr_b16 v[162:163], v3 offset:19968
    s_waitcnt lgkmcnt(14)
    v_mfma_f32_32x32x16_bf16 v[32:47], v[172:175], v[148:151], v[32:47]
    ds_read_b64_tr_b16 v[164:165], v3 offset:20480
    ds_read_b64_tr_b16 v[166:167], v3 offset:20992
    s_waitcnt lgkmcnt(14)
    v_mfma_f32_32x32x16_bf16 v[48:63], v[148:151], v[176:179], v[48:63]
    s_barrier
    ds_read_b128 v[148:151], v4 offset:16384
    ds_read_b64_tr_b16 v[168:169], v3 offset:24576
    ds_read_b64_tr_b16 v[170:171], v3 offset:25088
    s_waitcnt lgkmcnt(14)
    v_mfma_f32_32x32x16_bf16 v[16:31], v[180:183], v[152:155], v[16:31]
    ds_read_b64_tr_b16 v[172:173], v3 offset:25600
    ds_read_b64_tr_b16 v[174:175], v3 offset:26112
    s_waitcnt lgkmcnt(14)
    v_mfma_f32_32x32x16_bf16 v[32:47], v[184:187], v[152:155], v[32:47]
    ds_read_b32 v124, v14
    ds_read_b32 v125, v14
    ds_read_b64_tr_b16 v[176:177], v3 offset:26624
    ds_read_b64_tr_b16 v[178:179], v3 offset:27136
    s_waitcnt lgkmcnt(15)
    v_mfma_f32_32x32x16_bf16 v[48:63], v[152:155], v[188:191], v[48:63]
    ds_read_b32 v98, v14 offset:256
    ds_read_b128 v[152:155], v5 offset:16384
    ds_read_b64_tr_b16 v[180:181], v3 offset:30720
    ds_read_b64_tr_b16 v[182:183], v3 offset:31232
    s_waitcnt lgkmcnt(15)
    v_mfma_f32_32x32x16_bf16 v[16:31], v[156:159], v[144:147], v[16:31]
    ds_read_b64_tr_b16 v[184:185], v3 offset:31744
    ds_read_b64_tr_b16 v[186:187], v3 offset:32256
    v_mfma_f32_32x32x16_bf16 v[32:47], v[160:163], v[144:147], v[32:47]
    ds_read_b64_tr_b16 v[188:189], v3 offset:32768
    ds_read_b64_tr_b16 v[190:191], v3 offset:33280
    s_waitcnt lgkmcnt(15)
    v_mfma_f32_32x32x16_bf16 v[48:63], v[144:147], v[164:167], v[48:63]
    ds_read_b128 v[144:147], v6 offset:16384
    ds_read_b64_tr_b16 v[156:157], v3 offset:36864
    ds_read_b64_tr_b16 v[158:159], v3 offset:37376
    s_waitcnt lgkmcnt(15)
    v_mfma_f32_32x32x16_bf16 v[16:31], v[168:171], v[148:151], v[16:31]
    ds_read_b64_tr_b16 v[160:161], v3 offset:37888
    ds_read_b64_tr_b16 v[162:163], v3 offset:38400
    v_mfma_f32_32x32x16_bf16 v[32:47], v[172:175], v[148:151], v[32:47]
    s_waitcnt vmcnt(3)
    v_cmp_ne_u32 vcc, s40, v100
    s_cmp_eq_u64 vcc, 0
    s_cselect_b32 s39, 1, 0
    ds_read_b64_tr_b16 v[164:165], v3 offset:38912
    ds_read_b64_tr_b16 v[166:167], v3 offset:39424
    s_waitcnt lgkmcnt(15)
    v_mfma_f32_32x32x16_bf16 v[48:63], v[148:151], v[176:179], v[48:63]
    s_mov_b32 s41, 131072
    s_branch L_pchk_3
L_poll_1:
    buffer_load_dwordx2 v[212:213], v12, s[12:15], s99 offen offset:0 sc1
    buffer_load_dwordx2 v[214:215], v12, s[12:15], s99 offen offset:256 sc1
    buffer_load_dwordx2 v[216:217], v12, s[12:15], s99 offen offset:512 sc1
    s_waitcnt vmcnt(0)
L_pchk_3:
    s_waitcnt vmcnt(2)
    v_cmp_ne_u32 vcc, s36, v213
    s_waitcnt vmcnt(1)
    v_cmp_ne_u32 s[42:43], s36, v215
    s_or_b64 vcc, vcc, s[42:43]
    s_waitcnt vmcnt(0)
    v_cmp_ne_u32 s[42:43], s36, v217
    s_or_b64 vcc, vcc, s[42:43]
    s_cbranch_vccz L_pdone_2
    s_sub_u32 s41, s41, 1
    s_cbranch_scc0 L_poll_1
L_pdone_2:
    ds_read_b128 v[148:151], v7 offset:16384
    ds_read_b64_tr_b16 v[168:169], v3 offset:43008
    ds_read_b64_tr_b16 v[170:171], v3 offset:43520
    s_waitcnt lgkmcnt(14)
    v_mfma_f32_32x32x16_bf16 v[16:31], v[180:183], v[152:155], v[16:31]
    v_add_f32 v212, v212, v208
    v_and_b32 v104, 0xffff0000, v212
    v_sub_f32 v105, v212, v104
    v_cvt_pk_bf16_f32 v112, v104, v104
    v_cvt_pk_bf16_f32 v113, v105, v105
    ds_read_b64_tr_b16 v[172:173], v3 offset:44032
    ds_read_b64_tr_b16 v[174:175], v3 offset:44544
    s_waitcnt lgkmcnt(14)
    v_mfma_f32_32x32x16_bf16 v[32:47], v[184:187], v[152:155], v[32:47]
    v_add_f32 v214, v214, v209
    v_and_b32 v104, 0xffff0000, v214
    v_sub_f32 v105, v214, v104
    v_cvt_pk_bf16_f32 v116, v104, v104
    v_cvt_pk_bf16_f32 v117, v105, v105
    ds_read_b64_tr_b16 v[176:177], v3 offset:45056
    ds_read_b64_tr_b16 v[178:179], v3 offset:45568
    s_waitcnt lgkmcnt(14)
    v_mfma_f32_32x32x16_bf16 v[48:63], v[152:155], v[188:191], v[48:63]
    v_add_f32 v216, v216, v210
    v_and_b32 v104, 0xffff0000, v216
    v_sub_f32 v105, v216, v104
    v_cvt_pk_bf16_f32 v120, v104, v104
    v_cvt_pk_bf16_f32 v121, v105, v105
    s_waitcnt lgkmcnt(11)
    v_mfma_f32_32x32x16_bf16 v[16:31], v[156:159], v[144:147], v[16:31]
    v_mfma_f32_32x32x16_bf16 v[16:31], v[112:115], v[124:127], v[16:31]
    ds_read_b128 v[128:131], v15 offset:256
    s_waitcnt lgkmcnt(10)
    v_mfma_f32_32x32x16_bf16 v[32:47], v[160:163], v[144:147], v[32:47]
    v_mfma_f32_32x32x16_bf16 v[32:47], v[116:119], v[124:127], v[32:47]
    ds_read_b128 v[132:135], v15 offset:288
    s_waitcnt lgkmcnt(9)
    v_mfma_f32_32x32x16_bf16 v[48:63], v[144:147], v[164:167], v[48:63]
    v_mfma_f32_32x32x16_bf16 v[48:63], v[124:127], v[120:123], v[48:63]
    ds_read_b128 v[136:139], v15 offset:320
    s_waitcnt lgkmcnt(5)
    v_mfma_f32_32x32x16_bf16 v[32:47], v[172:175], v[148:151], v[32:47]
    ds_read_b128 v[140:143], v15 offset:352
    s_waitcnt lgkmcnt(4)
    v_mfma_f32_32x32x16_bf16 v[48:63], v[148:151], v[176:179], v[48:63]
    v_mfma_f32_32x32x16_bf16 v[16:31], v[168:171], v[148:151], v[16:31]
    s_barrier
    v_mul_f32 v96, 0x3eb8aa3b, v98
    s_nop 5
    v_pk_mul_f32 v[32:33], v[32:33], v[98:99] op_sel_hi:[1,0]
    v_pk_mul_f32 v[34:35], v[34:35], v[98:99] op_sel_hi:[1,0]
    v_pk_mul_f32 v[36:37], v[36:37], v[98:99] op_sel_hi:[1,0]
    v_pk_mul_f32 v[38:39], v[38:39], v[98:99] op_sel_hi:[1,0]
    v_pk_mul_f32 v[40:41], v[40:41], v[98:99] op_sel_hi:[1,0]
    v_pk_mul_f32 v[42:43], v[42:43], v[98:99] op_sel_hi:[1,0]
    v_pk_mul_f32 v[44:45], v[44:45], v[98:99] op_sel_hi:[1,0]
    v_pk_mul_f32 v[46:47], v[46:47], v[98:99] op_sel_hi:[1,0]
    v_cvt_pk_bf16_f32 v72, v32, v33
    v_cvt_pk_bf16_f32 v73, v34, v35
    v_cvt_pk_bf16_f32 v74, v36, v37
    v_cvt_pk_bf16_f32 v75, v38, v39
    v_cvt_pk_bf16_f32 v76, v40, v41
    v_cvt_pk_bf16_f32 v77, v42, v43
    v_cvt_pk_bf16_f32 v78, v44, v45
    v_cvt_pk_bf16_f32 v79, v46, v47
    s_cmp_lg_u32 s39, 0
    s_cbranch_scc1 L_fast_4
    buffer_store_dwordx4 v[72:75], v236, s[12:15], s51 offen sc1
    buffer_store_dwordx4 v[76:79], v236, s[12:15], s53 offen sc1
    s_branch L_fdone_5
L_fast_4:
    buffer_store_dwordx4 v[72:75], v236, s[12:15], s51 offen
    buffer_store_dwordx4 v[76:79], v236, s[12:15], s53 offen
L_fdone_5:
    s_waitcnt lgkmcnt(3)
    v_pk_mul_f32 v[48:49], v[48:49], v[128:129]
    v_pk_mul_f32 v[50:51], v[50:51], v[130:131]
    s_waitcnt lgkmcnt(2)
    v_pk_mul_f32 v[52:53], v[52:53], v[132:133]
    v_pk_mul_f32 v[54:55], v[54:55], v[134:135]
    s_waitcnt lgkmcnt(1)
    v_pk_mul_f32 v[56:57], v[56:57], v[136:137]
    v_pk_mul_f32 v[58:59], v[58:59], v[138:139]
    s_waitcnt lgkmcnt(0)
    v_pk_mul_f32 v[60:61], v[60:61], v[140:141]
    v_pk_mul_f32 v[62:63], v[62:63], v[142:143]
    v_cvt_pk_bf16_f32 v80, v48, v49
    v_cvt_pk_bf16_f32 v81, v50, v51
    v_cvt_pk_bf16_f32 v82, v52, v53
    v_cvt_pk_bf16_f32 v83, v54, v55
    v_cvt_pk_bf16_f32 v84, v56, v57
    v_cvt_pk_bf16_f32 v85, v58, v59
    v_cvt_pk_bf16_f32 v86, v60, v61
    v_cvt_pk_bf16_f32 v87, v62, v63
    s_cmp_lg_u32 s39, 0
    s_cbranch_scc1 L_fast_6
    buffer_store_dwordx4 v[80:83], v237, s[12:15], s51 offen offset:1024 sc1
    buffer_store_dwordx4 v[84:87], v237, s[12:15], s51 offen offset:1536 sc1
    s_branch L_fdone_7
L_fast_6:
    buffer_store_dwordx4 v[80:83], v237, s[12:15], s51 offen offset:1024
    buffer_store_dwordx4 v[84:87], v237, s[12:15], s51 offen offset:1536
L_fdone_7:
    v_pk_mul_f32 v[16:17], v[16:17], v[96:97] op_sel_hi:[1,0]
    v_pk_mul_f32 v[18:19], v[18:19], v[96:97] op_sel_hi:[1,0]
    v_pk_mul_f32 v[20:21], v[20:21], v[96:97] op_sel_hi:[1,0]
    v_pk_mul_f32 v[22:23], v[22:23], v[96:97] op_sel_hi:[1,0]
    v_pk_mul_f32 v[24:25], v[24:25], v[96:97] op_sel_hi:[1,0]
    v_pk_mul_f32 v[26:27], v[26:27], v[96:97] op_sel_hi:[1,0]
    v_pk_mul_f32 v[28:29], v[28:29], v[96:97] op_sel_hi:[1,0]
    v_pk_mul_f32 v[30:31], v[30:31], v[96:97] op_sel_hi:[1,0]
    v_cvt_pk_bf16_f32 v64, v16, v17
    v_cvt_pk_bf16_f32 v65, v18, v19
    v_cvt_pk_bf16_f32 v66, v20, v21
    v_cvt_pk_bf16_f32 v67, v22, v23
    v_cvt_pk_bf16_f32 v68, v24, v25
    v_cvt_pk_bf16_f32 v69, v26, v27
    v_cvt_pk_bf16_f32 v70, v28, v29
    v_cvt_pk_bf16_f32 v71, v30, v31
    s_cmp_lg_u32 s39, 0
    s_cbranch_scc1 L_fast_8
    buffer_store_dwordx4 v[64:67], v2, s[12:15], s50 offen sc1
    buffer_store_dwordx4 v[68:71], v2, s[12:15], s52 offen sc1
    s_branch L_fdone_9
L_fast_8:
    buffer_store_dwordx4 v[64:67], v2, s[12:15], s50 offen
    buffer_store_dwordx4 v[68:71], v2, s[12:15], s52 offen
L_fdone_9:
    s_lshl_b32 s59, s61, 3
    s_add_u32 s59, s59, s3
    s_lshr_b32 s60, s38, 3
    s_lshl_b32 s60, s60, 1
    s_lshl_b32 s50, s37, 3
    s_add_u32 s60, s60, s50
    s_and_b32 s50, s3, 1
    s_add_u32 s60, s60, s50
    v_mov_b32 v80, 0xdddddddd
    v_mov_b32 v81, v2
    v_add_u32 v83, 0x10000, v2
    v_and_b32 v82, 15, v1
    v_lshlrev_b32 v82, 4, v82
    v_lshrrev_b32 v84, 5, v1
    v_lshl_add_u32 v82, v84, 8, v82
    v_add_u32 v82, 1024, v82
    v_and_b32 v252, 31, v1
    v_lshlrev_b32 v90, 2, v252
    v_lshlrev_b32 v252, 10, v252
    v_lshl_add_u32 v252, v84, 4, v252
    v_add_u32 v84, 0x10000, v82
    s_lshl_b32 s62, s60, 15
    s_lshl_b32 s50, s61, 7
    s_add_u32 s62, s62, s50
    s_lshr_b32 s50, s3, 1
    s_lshl_b32 s50, s50, 5
    s_add_u32 s62, s62, s50
    s_bfe_u32 s50, s3, 0x10001
    s_lshl_b32 s50, s50, 8
    s_lshr_b32 s51, s3, 2
    s_lshl_b32 s51, s51, 10
    s_or_b32 s50, s50, s51
    v_xor_b32 v85, s50, v2
    v_xor_b32 v86, 1024, v85
    s_lshl_b32 s50, s3, 10
    s_add_u32 s50, s50, 131072
    v_add_u32 v253, s50, v2
    s_lshr_b32 s51, s3, 1
    s_lshl_b32 s51, s51, 14
    s_lshl_b32 s50, s61, 16
    s_add_u32 s51, s51, s50
    s_add_u32 s51, s51, 18874368
    s_mul_i32 s52, s3, 22528
    s_mul_i32 s50, s61, 180224
    s_add_u32 s52, s52, s50
    s_add_u32 s52, s52, 19922944
    s_mul_i32 s54, s3, 6144
    s_mul_i32 s53, s38, 98304
    s_add_u32 s53, s53, s54
    s_add_u32 s53, s53, 22020096
    s_cmp_ge_u32 s38, 29
    s_cselect_b32 s53, 1073741824, s53
    s_mov_b32 s48, 0x0000ffff
    s_mov_b32 s49, 0x0000ffff
    s_lshl_b32 s50, s37, 7
    s_add_u32 s50, s50, 20480
    v_add_u32 v91, s50, v90
    v_and_b32 v87, 7, v1
    v_lshlrev_b32 v87, 7, v87
    v_bfe_u32 v88, v1, 3, 2
    v_lshl_add_u32 v87, v88, 5, v87
    s_lshl_b32 s50, s37, 2
    s_add_u32 s50, s50, 20480
    s_mov_b32 exec_lo, 0
    v_add_u32 v91, s50, v87
    s_mov_b64 exec, -1
    s_lshl_b32 s55, s58, 17
    s_add_u32 s55, s55, 4194304
    s_lshl_b32 s47, s3, 11
    s_add_u32 s47, s47, 16384
    s_lshl_b32 s46, s3, 13
    s_add_u32 s46, s46, 65536
    s_waitcnt vmcnt(0)
    v_mov_b32 v3, s36
    s_mov_b64 exec, 1
    s_cmp_lg_u32 s39, 0
    s_cbranch_scc1 L_fast_10
    buffer_store_dword v3, off, s[12:15], s101 sc1
    s_branch L_fdone_11
L_fast_10:
    buffer_store_dword v3, off, s[12:15], s101
L_fdone_11:
    s_mov_b64 exec, -1
    v_mov_b32 v64, 0
    v_mov_b32 v65, 0
    v_mov_b32 v66, 0
    v_mov_b32 v67, 0
    v_mov_b32 v68, 0
    v_mov_b32 v69, 0
    v_mov_b32 v70, 0
    v_mov_b32 v71, 0
    v_mov_b32 v72, 0
    v_mov_b32 v73, 0
    v_mov_b32 v74, 0
    v_mov_b32 v75, 0
    v_mov_b32 v76, 0
    v_mov_b32 v77, 0
    v_mov_b32 v78, 0
    v_mov_b32 v79, 0
    v_mov_b32 v40, 0
    v_mov_b32 v41, 0
    v_mov_b32 v42, 0
    v_mov_b32 v43, 0
    v_mov_b32 v44, 0
    v_mov_b32 v45, 0
    v_mov_b32 v46, 0
    v_mov_b32 v47, 0
    v_mov_b32 v48, 0
    v_mov_b32 v49, 0
    v_mov_b32 v50, 0
    v_mov_b32 v51, 0
    v_mov_b32 v52, 0
    v_mov_b32 v53, 0
    v_mov_b32 v54, 0
    v_mov_b32 v55, 0
    v_mov_b32 v240, -1
    v_mov_b32 v241, -1
    v_mov_b32 v242, -1
    v_mov_b32 v243, -1
    s_mov_b32 exec_lo, 0x00110000
    s_mov_b32 exec_hi, 0x00110000
    v_mov_b32 v64, 0x3f803f80
    v_mov_b32 v65, 0x3f803f80
    v_mov_b32 v66, 0x3f803f80
    v_mov_b32 v67, 0x3f803f80
    v_mov_b32 v68, 0x3f803f80
    v_mov_b32 v69, 0x3f803f80
    v_mov_b32 v70, 0x3f803f80
    v_mov_b32 v71, 0x3f803f80
    v_mov_b32 v72, 0x3f803f80
    v_mov_b32 v73, 0x3f803f80
    v_mov_b32 v74, 0x3f803f80
    v_mov_b32 v75, 0x3f803f80
    v_mov_b32 v76, 0x3f803f80
    v_mov_b32 v77, 0x3f803f80
    v_mov_b32 v78, 0x3f803f80
    v_mov_b32 v79, 0x3f803f80
    s_mov_b64 exec, -1
    s_lshl_b32 s44, s56, 8
    s_add_u32 s44, s44, 8192
    v_lshlrev_b32 v9, 2, v1
    s_mov_b32 s41, 131072
L_poll_12:
    buffer_load_dword v11, v9, s[12:15], s44 offen sc1
    s_waitcnt vmcnt(0)
    v_cmp_ne_u32 vcc, s36, v11
    s_cbranch_vccz L_pdone_13
    s_sub_u32 s41, s41, 1
    s_cbranch_scc0 L_poll_12
L_pdone_13:
    s_lshl_b32 s42, s58, 6
    s_lshl_b32 s43, s61, 3
    s_add_u32 s42, s42, s43
    s_lshl_b32 s43, s3, 1
    s_add_u32 s42, s42, s43
    s_lshl_b32 s42, s42, 10
    s_add_u32 s42, s42, 1048576
    s_lshl_b32 s43, s3, 11
    s_add_u32 m0, s43, 131072
    s_lshl_b32 s43, s3, 12
    buffer_load_dwordx4 v2, s[12:15], s42 offen offset:0 sc1 lds
    buffer_load_dwordx4 v2, s[12:15], s42 offen offset:1024 sc1 lds
    s_lshl_b32 s42, s58, 17
    s_add_u32 s42, s42, s43
    s_add_u32 s42, s42, 4194304
    s_mov_b32 m0, s43
    s_nop 0
    buffer_load_dwordx4 v2, s[12:15], s42 offen offset:0 sc1 lds
    buffer_load_dwordx4 v2, s[12:15], s42 offen offset:1024 sc1 lds
    buffer_load_dwordx4 v2, s[12:15], s42 offen offset:2048 sc1 lds
    buffer_load_dwordx4 v2, s[12:15], s42 offen offset:3072 sc1 lds
    s_waitcnt vmcnt(0)
    s_barrier
    ds_read_b128 v[4:7], v253
    ds_read_b128 v[56:59], v81 offset:0
    ds_read_b128 v[60:63], v81 offset:2048
    s_mov_b64 exec, s[48:49]
    ds_read_b128 v[64:67], v82 offset:0
    ds_read_b128 v[68:71], v82 offset:512
    s_mov_b64 exec, -1
    s_waitcnt lgkmcnt(3)
    v_mfma_f32_32x32x16_bf16 v[8:23], v[56:59], v[4:7], 0
    s_setprio 2
    s_nop 10
    v_exp_f32 v8, v8
    v_exp_f32 v9, v9
    s_add_u32 m0, s47, 0
    s_add_u32 s45, s55, m0
    buffer_load_dwordx4 v2, s[12:15], s45 offen offset:0 sc1 lds
    s_sub_u32 m0, s45, s55
    s_nop 0
    buffer_load_dwordx4 v2, s[12:15], s45 offen offset:1024 sc1 lds
    v_exp_f32 v10, v10
    v_exp_f32 v11, v11
    v_exp_f32 v12, v12
    v_exp_f32 v13, v13
    v_exp_f32 v14, v14
    s_waitcnt lgkmcnt(2)
    v_mfma_f32_32x32x16_bf16 v[24:39], v[60:63], v[4:7], 0
    ds_read_b128 v[56:59], v81 offset:4096
    v_exp_f32 v15, v15
    v_exp_f32 v16, v16
    v_exp_f32 v17, v17
    v_exp_f32 v18, v18
    v_exp_f32 v19, v19
    s_waitcnt lgkmcnt(2)
    v_smfmac_f32_32x32x32_bf16 v[40:55], v[64:67], v[8:15], v80
    s_mov_b64 exec, s[48:49]
    ds_read_b128 v[72:75], v82 offset:2048
    ds_read_b128 v[76:79], v82 offset:2560
    s_mov_b64 exec, -1
    v_exp_f32 v20, v20
    v_exp_f32 v21, v21
    v_exp_f32 v22, v22
    v_exp_f32 v23, v23
    v_exp_f32 v24, v24
    v_exp_f32 v25, v25
    s_waitcnt lgkmcnt(3)
    v_smfmac_f32_32x32x32_bf16 v[40:55], v[68:71], v[16:23], v80
    s_add_u32 m0, s47, 16384
    s_add_u32 s45, s55, m0
    buffer_load_dwordx4 v2, s[12:15], s45 offen offset:0 sc1 lds
    s_sub_u32 m0, s45, s55
    s_nop 0
    buffer_load_dwordx4 v2, s[12:15], s45 offen offset:1024 sc1 lds
    v_exp_f32 v26, v26
    v_exp_f32 v27, v27
    v_exp_f32 v28, v28
    v_exp_f32 v29, v29
    v_exp_f32 v30, v30
    s_waitcnt lgkmcnt(2)
    v_mfma_f32_32x32x16_bf16 v[8:23], v[56:59], v[4:7], 0
    ds_read_b128 v[60:63], v81 offset:6144
    v_exp_f32 v31, v31
    v_exp_f32 v32, v32
    v_exp_f32 v33, v33
    v_exp_f32 v34, v34
    v_exp_f32 v35, v35
    s_waitcnt lgkmcnt(2)
    v_smfmac_f32_32x32x32_bf16 v[40:55], v[72:75], v[24:31], v80
    s_mov_b64 exec, s[48:49]
    ds_read_b128 v[64:67], v82 offset:4096
    ds_read_b128 v[68:71], v82 offset:4608
    s_mov_b64 exec, -1
    v_exp_f32 v36, v36
    v_exp_f32 v37, v37
    v_exp_f32 v38, v38
    v_exp_f32 v39, v39
    v_exp_f32 v8, v8
    v_exp_f32 v9, v9
    s_waitcnt lgkmcnt(3)
    v_smfmac_f32_32x32x32_bf16 v[40:55], v[76:79], v[32:39], v80
    s_add_u32 m0, s47, 32768
    s_add_u32 s45, s55, m0
    buffer_load_dwordx4 v2, s[12:15], s45 offen offset:0 sc1 lds
    s_sub_u32 m0, s45, s55
    s_nop 0
    buffer_load_dwordx4 v2, s[12:15], s45 offen offset:1024 sc1 lds
    v_exp_f32 v10, v10
    v_exp_f32 v11, v11
    v_exp_f32 v12, v12
    v_exp_f32 v13, v13
    v_exp_f32 v14, v14
    s_waitcnt lgkmcnt(2)
    v_mfma_f32_32x32x16_bf16 v[24:39], v[60:63], v[4:7], 0
    ds_read_b128 v[56:59], v81 offset:8192
    v_exp_f32 v15, v15
    v_exp_f32 v16, v16
    v_exp_f32 v17, v17
    v_exp_f32 v18, v18
    v_exp_f32 v19, v19
    s_waitcnt lgkmcnt(2)
    v_smfmac_f32_32x32x32_bf16 v[40:55], v[64:67], v[8:15], v80
    s_mov_b64 exec, s[48:49]
    ds_read_b128 v[72:75], v82 offset:6144
    ds_read_b128 v[76:79], v82 offset:6656
    s_mov_b64 exec, -1
    v_exp_f32 v20, v20
    v_exp_f32 v21, v21
    v_exp_f32 v22, v22
    v_exp_f32 v23, v23
    s_setprio 0
    v_exp_f32 v24, v24
    v_exp_f32 v25, v25
    s_waitcnt lgkmcnt(3)
    v_smfmac_f32_32x32x32_bf16 v[40:55], v[68:71], v[16:23], v80
    s_add_u32 m0, s46, 0
    s_add_u32 s45, s55, m0
    buffer_load_dwordx4 v2, s[12:15], s45 offen offset:0 sc1 lds
    v_exp_f32 v26, v26
    v_exp_f32 v27, v27
    v_exp_f32 v28, v28
    v_exp_f32 v29, v29
    v_exp_f32 v30, v30
    s_waitcnt lgkmcnt(2)
    v_mfma_f32_32x32x16_bf16 v[8:23], v[56:59], v[4:7], 0
    ds_read_b128 v[60:63], v81 offset:10240
    v_exp_f32 v31, v31
    v_exp_f32 v32, v32
    v_exp_f32 v33, v33
    v_exp_f32 v34, v34
    v_exp_f32 v35, v35
    s_waitcnt lgkmcnt(2)
    v_smfmac_f32_32x32x32_bf16 v[40:55], v[72:75], v[24:31], v80
    s_mov_b64 exec, s[48:49]
    ds_read_b128 v[64:67], v82 offset:8192
    ds_read_b128 v[68:71], v82 offset:8704
    s_mov_b64 exec, -1
    v_exp_f32 v36, v36
    v_exp_f32 v37, v37
    v_exp_f32 v38, v38
    v_exp_f32 v39, v39
    s_setprio 2
    v_exp_f32 v8, v8
    v_exp_f32 v9, v9
    s_waitcnt lgkmcnt(3)
    v_smfmac_f32_32x32x32_bf16 v[40:55], v[76:79], v[32:39], v80
    s_sub_u32 m0, s45, s55
    s_nop 0
    buffer_load_dwordx4 v2, s[12:15], s45 offen offset:1024 sc1 lds
    v_exp_f32 v10, v10
    v_exp_f32 v11, v11
    v_exp_f32 v12, v12
    v_exp_f32 v13, v13
    v_exp_f32 v14, v14
    s_waitcnt lgkmcnt(2)
    v_mfma_f32_32x32x16_bf16 v[24:39], v[60:63], v[4:7], 0
    ds_read_b128 v[56:59], v81 offset:12288
    v_exp_f32 v15, v15
    v_exp_f32 v16, v16
    v_exp_f32 v17, v17
    v_exp_f32 v18, v18
    v_exp_f32 v19, v19
    s_waitcnt lgkmcnt(2)
    v_smfmac_f32_32x32x32_bf16 v[40:55], v[64:67], v[8:15], v80
    s_mov_b64 exec, s[48:49]
    ds_read_b128 v[72:75], v82 offset:10240
    ds_read_b128 v[76:79], v82 offset:10752
    s_mov_b64 exec, -1
    v_exp_f32 v20, v20
    v_exp_f32 v21, v21
    v_exp_f32 v22, v22
    v_exp_f32 v23, v23
    v_exp_f32 v24, v24
    v_exp_f32 v25, v25
    s_waitcnt lgkmcnt(3)
    v_smfmac_f32_32x32x32_bf16 v[40:55], v[68:71], v[16:23], v80
    s_sub_u32 m0, s45, s55
    s_nop 0
    buffer_load_dwordx4 v2, s[12:15], s45 offen offset:2048 sc1 lds
    v_exp_f32 v26, v26
    v_exp_f32 v27, v27
    v_exp_f32 v28, v28
    v_exp_f32 v29, v29
    v_exp_f32 v30, v30
    s_waitcnt lgkmcnt(2)
    v_mfma_f32_32x32x16_bf16 v[8:23], v[56:59], v[4:7], 0
    ds_read_b128 v[60:63], v81 offset:14336
    v_exp_f32 v31, v31
    v_exp_f32 v32, v32
    v_exp_f32 v33, v33
    v_exp_f32 v34, v34
    v_exp_f32 v35, v35
    s_waitcnt lgkmcnt(2)
    v_smfmac_f32_32x32x32_bf16 v[40:55], v[72:75], v[24:31], v80
    s_mov_b64 exec, s[48:49]
    ds_read_b128 v[64:67], v82 offset:12288
    ds_read_b128 v[68:71], v82 offset:12800
    s_mov_b64 exec, -1
    v_exp_f32 v36, v36
    v_exp_f32 v37, v37
    v_exp_f32 v38, v38
    v_exp_f32 v39, v39
    s_waitcnt vmcnt(7)
    s_barrier
    v_exp_f32 v8, v8
    v_exp_f32 v9, v9
    s_waitcnt lgkmcnt(3)
    v_smfmac_f32_32x32x32_bf16 v[40:55], v[76:79], v[32:39], v80
    s_sub_u32 m0, s45, s55
    s_nop 0
    buffer_load_dwordx4 v2, s[12:15], s45 offen offset:3072 sc1 lds
    v_exp_f32 v10, v10
    v_exp_f32 v11, v11
    v_exp_f32 v12, v12
    v_exp_f32 v13, v13
    v_exp_f32 v14, v14
    s_waitcnt lgkmcnt(2)
    v_mfma_f32_32x32x16_bf16 v[24:39], v[60:63], v[4:7], 0
    ds_read_b128 v[56:59], v81 offset:16384
    v_exp_f32 v15, v15
    v_exp_f32 v16, v16
    v_exp_f32 v17, v17
    v_exp_f32 v18, v18
    v_exp_f32 v19, v19
    s_waitcnt lgkmcnt(2)
    v_smfmac_f32_32x32x32_bf16 v[40:55], v[64:67], v[8:15], v80
    s_mov_b64 exec, s[48:49]
    ds_read_b128 v[72:75], v82 offset:14336
    ds_read_b128 v[76:79], v82 offset:14848
    s_mov_b64 exec, -1
    v_exp_f32 v20, v20
    v_exp_f32 v21, v21
    v_exp_f32 v22, v22
    v_exp_f32 v23, v23
    s_setprio 0
    v_exp_f32 v24, v24
    v_exp_f32 v25, v25
    s_waitcnt lgkmcnt(3)
    v_smfmac_f32_32x32x32_bf16 v[40:55], v[68:71], v[16:23], v80
    s_add_u32 m0, s46, 4096
    s_add_u32 s45, s55, m0
    buffer_load_dwordx4 v2, s[12:15], s45 offen offset:0 sc1 lds
    v_exp_f32 v26, v26
    v_exp_f32 v27, v27
    v_exp_f32 v28, v28
    v_exp_f32 v29, v29
    v_exp_f32 v30, v30
    s_waitcnt lgkmcnt(2)
    v_mfma_f32_32x32x16_bf16 v[8:23], v[56:59], v[4:7], 0
    ds_read_b128 v[60:63], v81 offset:18432
    v_exp_f32 v31, v31
    v_exp_f32 v32, v32
    v_exp_f32 v33, v33
    v_exp_f32 v34, v34
    v_exp_f32 v35, v35
    s_waitcnt lgkmcnt(2)
    v_smfmac_f32_32x32x32_bf16 v[40:55], v[72:75], v[24:31], v80
    s_mov_b64 exec, s[48:49]
    ds_read_b128 v[64:67], v82 offset:16384
    ds_read_b128 v[68:71], v82 offset:16896
    s_mov_b64 exec, -1
    v_exp_f32 v36, v36
    v_exp_f32 v37, v37
    v_exp_f32 v38, v38
    v_exp_f32 v39, v39
    s_setprio 2
    v_exp_f32 v8, v8
    v_exp_f32 v9, v9
    s_waitcnt lgkmcnt(3)
    v_smfmac_f32_32x32x32_bf16 v[40:55], v[76:79], v[32:39], v80
    s_sub_u32 m0, s45, s55
    s_nop 0
    buffer_load_dwordx4 v2, s[12:15], s45 offen offset:1024 sc1 lds
    v_exp_f32 v10, v10
    v_exp_f32 v11, v11
    v_exp_f32 v12, v12
    v_exp_f32 v13, v13
    v_exp_f32 v14, v14
    s_waitcnt lgkmcnt(2)
    v_mfma_f32_32x32x16_bf16 v[24:39], v[60:63], v[4:7], 0
    ds_read_b128 v[56:59], v81 offset:20480
    v_exp_f32 v15, v15
    v_exp_f32 v16, v16
    v_exp_f32 v17, v17
    v_exp_f32 v18, v18
    v_exp_f32 v19, v19
    s_waitcnt lgkmcnt(2)
    v_smfmac_f32_32x32x32_bf16 v[40:55], v[64:67], v[8:15], v80
    s_mov_b64 exec, s[48:49]
    ds_read_b128 v[72:75], v82 offset:18432
    ds_read_b128 v[76:79], v82 offset:18944
    s_mov_b64 exec, -1
    v_exp_f32 v20, v20
    v_exp_f32 v21, v21
    v_exp_f32 v22, v22
    v_exp_f32 v23, v23
    v_exp_f32 v24, v24
    v_exp_f32 v25, v25
    s_waitcnt lgkmcnt(3)
    v_smfmac_f32_32x32x32_bf16 v[40:55], v[68:71], v[16:23], v80
    s_sub_u32 m0, s45, s55
    s_nop 0
    buffer_load_dwordx4 v2, s[12:15], s45 offen offset:2048 sc1 lds
    v_exp_f32 v26, v26
    v_exp_f32 v27, v27
    v_exp_f32 v28, v28
    v_exp_f32 v29, v29
    v_exp_f32 v30, v30
    s_waitcnt lgkmcnt(2)
    v_mfma_f32_32x32x16_bf16 v[8:23], v[56:59], v[4:7], 0
    ds_read_b128 v[60:63], v81 offset:22528
    v_exp_f32 v31, v31
    v_exp_f32 v32, v32
    v_exp_f32 v33, v33
    v_exp_f32 v34, v34
    v_exp_f32 v35, v35
    s_waitcnt lgkmcnt(2)
    v_smfmac_f32_32x32x32_bf16 v[40:55], v[72:75], v[24:31], v80
    s_mov_b64 exec, s[48:49]
    ds_read_b128 v[64:67], v82 offset:20480
    ds_read_b128 v[68:71], v82 offset:20992
    s_mov_b64 exec, -1
    v_exp_f32 v36, v36
    v_exp_f32 v37, v37
    v_exp_f32 v38, v38
    v_exp_f32 v39, v39
    v_exp_f32 v8, v8
    v_exp_f32 v9, v9
    s_waitcnt lgkmcnt(3)
    v_smfmac_f32_32x32x32_bf16 v[40:55], v[76:79], v[32:39], v80
    s_sub_u32 m0, s45, s55
    s_nop 0
    buffer_load_dwordx4 v2, s[12:15], s45 offen offset:3072 sc1 lds
    v_exp_f32 v10, v10
    v_exp_f32 v11, v11
    v_exp_f32 v12, v12
    v_exp_f32 v13, v13
    v_exp_f32 v14, v14
    s_waitcnt lgkmcnt(2)
    v_mfma_f32_32x32x16_bf16 v[24:39], v[60:63], v[4:7], 0
    ds_read_b128 v[56:59], v81 offset:24576
    v_exp_f32 v15, v15
    v_exp_f32 v16, v16
    v_exp_f32 v17, v17
    v_exp_f32 v18, v18
    v_exp_f32 v19, v19
    s_waitcnt lgkmcnt(2)
    v_smfmac_f32_32x32x32_bf16 v[40:55], v[64:67], v[8:15], v80
    s_mov_b64 exec, s[48:49]
    ds_read_b128 v[72:75], v82 offset:22528
    ds_read_b128 v[76:79], v82 offset:23040
    s_mov_b64 exec, -1
    v_exp_f32 v20, v20
    v_exp_f32 v21, v21
    v_exp_f32 v22, v22
    v_exp_f32 v23, v23
    s_setprio 0
    v_exp_f32 v24, v24
    v_exp_f32 v25, v25
    s_waitcnt lgkmcnt(3)
    v_smfmac_f32_32x32x32_bf16 v[40:55], v[68:71], v[16:23], v80
    s_lshl_b32 s44, s37, 7
    s_add_u32 s44, s44, 4096
    buffer_load_dword v89, v90, s[12:15], s44 offen sc1
    v_exp_f32 v26, v26
    v_exp_f32 v27, v27
    v_exp_f32 v28, v28
    v_exp_f32 v29, v29
    v_exp_f32 v30, v30
    s_waitcnt lgkmcnt(2)
    v_mfma_f32_32x32x16_bf16 v[8:23], v[56:59], v[4:7], 0
    ds_read_b128 v[60:63], v81 offset:26624
    v_exp_f32 v31, v31
    v_exp_f32 v32, v32
    v_exp_f32 v33, v33
    v_exp_f32 v34, v34
    v_exp_f32 v35, v35
    s_waitcnt lgkmcnt(2)
    v_smfmac_f32_32x32x32_bf16 v[40:55], v[72:75], v[24:31], v80
    s_mov_b64 exec, s[48:49]
    ds_read_b128 v[64:67], v82 offset:24576
    ds_read_b128 v[68:71], v82 offset:25088
    s_mov_b64 exec, -1
    v_exp_f32 v36, v36
    v_exp_f32 v37, v37
    v_exp_f32 v38, v38
    v_exp_f32 v39, v39
    s_setprio 2
    v_exp_f32 v8, v8
    v_exp_f32 v9, v9
    s_waitcnt lgkmcnt(3)
    v_smfmac_f32_32x32x32_bf16 v[40:55], v[76:79], v[32:39], v80
    v_exp_f32 v10, v10
    v_exp_f32 v11, v11
    v_exp_f32 v12, v12
    v_exp_f32 v13, v13
    v_exp_f32 v14, v14
    s_waitcnt lgkmcnt(2)
    v_mfma_f32_32x32x16_bf16 v[24:39], v[60:63], v[4:7], 0
    ds_read_b128 v[56:59], v81 offset:28672
    v_exp_f32 v15, v15
    v_exp_f32 v16, v16
    v_exp_f32 v17, v17
    v_exp_f32 v18, v18
    v_exp_f32 v19, v19
    s_waitcnt lgkmcnt(2)
    v_smfmac_f32_32x32x32_bf16 v[40:55], v[64:67], v[8:15], v80
    s_mov_b64 exec, s[48:49]
    ds_read_b128 v[72:75], v82 offset:26624
    ds_read_b128 v[76:79], v82 offset:27136
    s_mov_b64 exec, -1
    v_exp_f32 v20, v20
    v_exp_f32 v21, v21
    v_exp_f32 v22, v22
    v_exp_f32 v23, v23
    v_exp_f32 v24, v24
    v_exp_f32 v25, v25
    s_waitcnt lgkmcnt(3)
    v_smfmac_f32_32x32x32_bf16 v[40:55], v[68:71], v[16:23], v80
    v_exp_f32 v26, v26
    v_exp_f32 v27, v27
    v_exp_f32 v28, v28
    v_exp_f32 v29, v29
    v_exp_f32 v30, v30
    s_waitcnt lgkmcnt(2)
    v_mfma_f32_32x32x16_bf16 v[8:23], v[56:59], v[4:7], 0
    ds_read_b128 v[60:63], v81 offset:30720
    v_exp_f32 v31, v31
    v_exp_f32 v32, v32
    v_exp_f32 v33, v33
    v_exp_f32 v34, v34
    v_exp_f32 v35, v35
    s_waitcnt lgkmcnt(2)
    v_smfmac_f32_32x32x32_bf16 v[40:55], v[72:75], v[24:31], v80
    s_mov_b64 exec, s[48:49]
    ds_read_b128 v[64:67], v82 offset:28672
    ds_read_b128 v[68:71], v82 offset:29184
    s_mov_b64 exec, -1
    v_exp_f32 v36, v36
    v_exp_f32 v37, v37
    v_exp_f32 v38, v38
    v_exp_f32 v39, v39
    s_waitcnt vmcnt(9)
    s_barrier
    v_exp_f32 v8, v8
    v_exp_f32 v9, v9
    s_waitcnt lgkmcnt(3)
    v_smfmac_f32_32x32x32_bf16 v[40:55], v[76:79], v[32:39], v80
    s_waitcnt vmcnt(0)
    v_cmp_ne_u32 vcc, s40, v89
    s_cmp_eq_u64 vcc, 0
    s_cselect_b32 s39, 1, 0
    s_lshl_b32 s42, s59, 5
    s_add_u32 s42, s42, s58
    s_lshl_b32 s42, s42, 10
    s_add_u32 s42, s42, 8388608
    buffer_store_dwordx4 v[240:243], v2, s[12:15], s42 offen sc1
    v_exp_f32 v10, v10
    v_exp_f32 v11, v11
    v_exp_f32 v12, v12
    v_exp_f32 v13, v13
    v_exp_f32 v14, v14
    s_waitcnt lgkmcnt(2)
    v_mfma_f32_32x32x16_bf16 v[24:39], v[60:63], v[4:7], 0
    ds_read_b128 v[56:59], v81 offset:32768
    v_exp_f32 v15, v15
    v_exp_f32 v16, v16
    v_exp_f32 v17, v17
    v_exp_f32 v18, v18
    v_exp_f32 v19, v19
    s_waitcnt lgkmcnt(2)
    v_smfmac_f32_32x32x32_bf16 v[40:55], v[64:67], v[8:15], v80
    s_mov_b64 exec, s[48:49]
    ds_read_b128 v[72:75], v82 offset:30720
    ds_read_b128 v[76:79], v82 offset:31232
    s_mov_b64 exec, -1
    buffer_load_dwordx4 v[92:95], v85, s[12:15], s51 offen offset:0
    v_exp_f32 v20, v20
    v_exp_f32 v21, v21
    v_exp_f32 v22, v22
    v_exp_f32 v23, v23
    s_setprio 0
    v_exp_f32 v24, v24
    v_exp_f32 v25, v25
    s_waitcnt lgkmcnt(3)
    v_smfmac_f32_32x32x32_bf16 v[40:55], v[68:71], v[16:23], v80
    buffer_load_dwordx4 v[96:99], v86, s[12:15], s51 offen offset:0
    v_exp_f32 v26, v26
    v_exp_f32 v27, v27
    v_exp_f32 v28, v28
    v_exp_f32 v29, v29
    v_exp_f32 v30, v30
    s_waitcnt lgkmcnt(2)
    v_mfma_f32_32x32x16_bf16 v[8:23], v[56:59], v[4:7], 0
    ds_read_b128 v[60:63], v81 offset:34816
    v_exp_f32 v31, v31
    v_exp_f32 v32, v32
    v_exp_f32 v33, v33
    v_exp_f32 v34, v34
    v_exp_f32 v35, v35
    s_waitcnt lgkmcnt(2)
    v_smfmac_f32_32x32x32_bf16 v[40:55], v[72:75], v[24:31], v80
    s_mov_b64 exec, s[48:49]
    ds_read_b128 v[64:67], v82 offset:32768
    ds_read_b128 v[68:71], v82 offset:33280
    s_mov_b64 exec, -1
    v_exp_f32 v36, v36
    v_exp_f32 v37, v37
    v_exp_f32 v38, v38
    v_exp_f32 v39, v39
    s_setprio 2
    v_exp_f32 v8, v8
    v_exp_f32 v9, v9
    s_waitcnt lgkmcnt(3)
    v_smfmac_f32_32x32x32_bf16 v[40:55], v[76:79], v[32:39], v80
    buffer_load_dwordx4 v[100:103], v85, s[12:15], s51 offen offset:2048
    v_exp_f32 v10, v10
    v_exp_f32 v11, v11
    v_exp_f32 v12, v12
    v_exp_f32 v13, v13
    v_exp_f32 v14, v14
    s_waitcnt lgkmcnt(2)
    v_mfma_f32_32x32x16_bf16 v[24:39], v[60:63], v[4:7], 0
    ds_read_b128 v[56:59], v81 offset:36864
    v_exp_f32 v15, v15
    v_exp_f32 v16, v16
    v_exp_f32 v17, v17
    v_exp_f32 v18, v18
    v_exp_f32 v19, v19
    s_waitcnt lgkmcnt(2)
    v_smfmac_f32_32x32x32_bf16 v[40:55], v[64:67], v[8:15], v80
    s_mov_b64 exec, s[48:49]
    ds_read_b128 v[72:75], v82 offset:34816
    ds_read_b128 v[76:79], v82 offset:35328
    s_mov_b64 exec, -1
    v_exp_f32 v20, v20
    v_exp_f32 v21, v21
    v_exp_f32 v22, v22
    v_exp_f32 v23, v23
    v_exp_f32 v24, v24
    v_exp_f32 v25, v25
    s_waitcnt lgkmcnt(3)
    v_smfmac_f32_32x32x32_bf16 v[40:55], v[68:71], v[16:23], v80
    buffer_load_dwordx4 v[104:107], v86, s[12:15], s51 offen offset:2048
    s_add_u32 s51, s51, 4096
    v_exp_f32 v26, v26
    v_exp_f32 v27, v27
    v_exp_f32 v28, v28
    v_exp_f32 v29, v29
    v_exp_f32 v30, v30
    s_waitcnt lgkmcnt(2)
    v_mfma_f32_32x32x16_bf16 v[8:23], v[56:59], v[4:7], 0
    ds_read_b128 v[60:63], v81 offset:38912
    v_exp_f32 v31, v31
    v_exp_f32 v32, v32
    v_exp_f32 v33, v33
    v_exp_f32 v34, v34
    v_exp_f32 v35, v35
    s_waitcnt lgkmcnt(2)
    v_smfmac_f32_32x32x32_bf16 v[40:55], v[72:75], v[24:31], v80
    s_mov_b64 exec, s[48:49]
    ds_read_b128 v[64:67], v82 offset:36864
    ds_read_b128 v[68:71], v82 offset:37376
    s_mov_b64 exec, -1
    v_exp_f32 v36, v36
    v_exp_f32 v37, v37
    v_exp_f32 v38, v38
    v_exp_f32 v39, v39
    v_exp_f32 v8, v8
    v_exp_f32 v9, v9
    s_waitcnt lgkmcnt(3)
    v_smfmac_f32_32x32x32_bf16 v[40:55], v[76:79], v[32:39], v80
    buffer_load_dwordx4 v[108:111], v85, s[12:15], s51 offen offset:0
    v_exp_f32 v10, v10
    v_exp_f32 v11, v11
    v_exp_f32 v12, v12
    v_exp_f32 v13, v13
    v_exp_f32 v14, v14
    s_waitcnt lgkmcnt(2)
    v_mfma_f32_32x32x16_bf16 v[24:39], v[60:63], v[4:7], 0
    ds_read_b128 v[56:59], v81 offset:40960
    v_exp_f32 v15, v15
    v_exp_f32 v16, v16
    v_exp_f32 v17, v17
    v_exp_f32 v18, v18
    v_exp_f32 v19, v19
    s_waitcnt lgkmcnt(2)
    v_smfmac_f32_32x32x32_bf16 v[40:55], v[64:67], v[8:15], v80
    s_mov_b64 exec, s[48:49]
    ds_read_b128 v[72:75], v82 offset:38912
    ds_read_b128 v[76:79], v82 offset:39424
    s_mov_b64 exec, -1
    v_exp_f32 v20, v20
    v_exp_f32 v21, v21
    v_exp_f32 v22, v22
    v_exp_f32 v23, v23
    s_setprio 0
    v_exp_f32 v24, v24
    v_exp_f32 v25, v25
    s_waitcnt lgkmcnt(3)
    v_smfmac_f32_32x32x32_bf16 v[40:55], v[68:71], v[16:23], v80
    buffer_load_dwordx4 v[112:115], v86, s[12:15], s51 offen offset:0
    v_exp_f32 v26, v26
    v_exp_f32 v27, v27
    v_exp_f32 v28, v28
    v_exp_f32 v29, v29
    v_exp_f32 v30, v30
    s_waitcnt lgkmcnt(2)
    v_mfma_f32_32x32x16_bf16 v[8:23], v[56:59], v[4:7], 0
    ds_read_b128 v[60:63], v81 offset:43008
    v_exp_f32 v31, v31
    v_exp_f32 v32, v32
    v_exp_f32 v33, v33
    v_exp_f32 v34, v34
    v_exp_f32 v35, v35
    s_waitcnt lgkmcnt(2)
    v_smfmac_f32_32x32x32_bf16 v[40:55], v[72:75], v[24:31], v80
    s_mov_b64 exec, s[48:49]
    ds_read_b128 v[64:67], v82 offset:40960
    ds_read_b128 v[68:71], v82 offset:41472
    s_mov_b64 exec, -1
    v_exp_f32 v36, v36
    v_exp_f32 v37, v37
    v_exp_f32 v38, v38
    v_exp_f32 v39, v39
    s_setprio 2
    v_exp_f32 v8, v8
    v_exp_f32 v9, v9
    s_waitcnt lgkmcnt(3)
    v_smfmac_f32_32x32x32_bf16 v[40:55], v[76:79], v[32:39], v80
    s_lshl_b32 s43, s60, 3
    s_add_u32 s43, s43, s61
    s_lshl_b32 s43, s43, 2
    s_lshr_b32 s44, s3, 1
    s_add_u32 s43, s43, s44
    s_lshl_b32 s43, s43, 10
    s_add_u32 s43, s43, 10485760
    s_cmp_lg_u32 s39, 0
    s_cbranch_scc1 L_fast_15
    buffer_store_dwordx4 v[240:243], v2, s[12:15], s43 offen sc1
    s_branch L_fdone_16
L_fast_15:
    buffer_store_dwordx4 v[240:243], v2, s[12:15], s43 offen
L_fdone_16:
    v_exp_f32 v10, v10
    v_exp_f32 v11, v11
    v_exp_f32 v12, v12
    v_exp_f32 v13, v13
    v_exp_f32 v14, v14
    s_waitcnt lgkmcnt(2)
    v_mfma_f32_32x32x16_bf16 v[24:39], v[60:63], v[4:7], 0
    ds_read_b128 v[56:59], v81 offset:45056
    v_exp_f32 v15, v15
    v_exp_f32 v16, v16
    v_exp_f32 v17, v17
    v_exp_f32 v18, v18
    v_exp_f32 v19, v19
    s_waitcnt lgkmcnt(2)
    v_smfmac_f32_32x32x32_bf16 v[40:55], v[64:67], v[8:15], v80
    s_mov_b64 exec, s[48:49]
    ds_read_b128 v[72:75], v82 offset:43008
    ds_read_b128 v[76:79], v82 offset:43520
    s_mov_b64 exec, -1
    buffer_load_dwordx4 v[116:119], v85, s[12:15], s51 offen offset:2048
    v_exp_f32 v20, v20
    v_exp_f32 v21, v21
    v_exp_f32 v22, v22
    v_exp_f32 v23, v23
    v_exp_f32 v24, v24
    v_exp_f32 v25, v25
    s_waitcnt lgkmcnt(3)
    v_smfmac_f32_32x32x32_bf16 v[40:55], v[68:71], v[16:23], v80
    buffer_load_dwordx4 v[120:123], v86, s[12:15], s51 offen offset:2048
    s_add_u32 s51, s51, 4096
    v_exp_f32 v26, v26
    v_exp_f32 v27, v27
    v_exp_f32 v28, v28
    v_exp_f32 v29, v29
    v_exp_f32 v30, v30
    s_waitcnt lgkmcnt(2)
    v_mfma_f32_32x32x16_bf16 v[8:23], v[56:59], v[4:7], 0
    ds_read_b128 v[60:63], v81 offset:47104
    v_exp_f32 v31, v31
    v_exp_f32 v32, v32
    v_exp_f32 v33, v33
    v_exp_f32 v34, v34
    v_exp_f32 v35, v35
    s_waitcnt lgkmcnt(2)
    v_smfmac_f32_32x32x32_bf16 v[40:55], v[72:75], v[24:31], v80
    s_mov_b64 exec, s[48:49]
    ds_read_b128 v[64:67], v82 offset:45056
    ds_read_b128 v[68:71], v82 offset:45568
    s_mov_b64 exec, -1
    v_exp_f32 v36, v36
    v_exp_f32 v37, v37
    v_exp_f32 v38, v38
    v_exp_f32 v39, v39
    v_exp_f32 v8, v8
    v_exp_f32 v9, v9
    s_waitcnt lgkmcnt(3)
    v_smfmac_f32_32x32x32_bf16 v[40:55], v[76:79], v[32:39], v80
    buffer_load_dwordx4 v[124:127], v85, s[12:15], s51 offen offset:0
    v_exp_f32 v10, v10
    v_exp_f32 v11, v11
    v_exp_f32 v12, v12
    v_exp_f32 v13, v13
    v_exp_f32 v14, v14
    s_waitcnt lgkmcnt(2)
    v_mfma_f32_32x32x16_bf16 v[24:39], v[60:63], v[4:7], 0
    ds_read_b128 v[56:59], v81 offset:49152
    v_exp_f32 v15, v15
    v_exp_f32 v16, v16
    v_exp_f32 v17, v17
    v_exp_f32 v18, v18
    v_exp_f32 v19, v19
    s_waitcnt lgkmcnt(2)
    v_smfmac_f32_32x32x32_bf16 v[40:55], v[64:67], v[8:15], v80
    s_mov_b64 exec, s[48:49]
    ds_read_b128 v[72:75], v82 offset:47104
    ds_read_b128 v[76:79], v82 offset:47616
    s_mov_b64 exec, -1
    v_exp_f32 v20, v20
    v_exp_f32 v21, v21
    v_exp_f32 v22, v22
    v_exp_f32 v23, v23
    s_setprio 0
    v_exp_f32 v24, v24
    v_exp_f32 v25, v25
    s_waitcnt lgkmcnt(3)
    v_smfmac_f32_32x32x32_bf16 v[40:55], v[68:71], v[16:23], v80
    buffer_load_dwordx4 v[128:131], v86, s[12:15], s51 offen offset:0
    v_exp_f32 v26, v26
    v_exp_f32 v27, v27
    v_exp_f32 v28, v28
    v_exp_f32 v29, v29
    v_exp_f32 v30, v30
    s_waitcnt lgkmcnt(2)
    v_mfma_f32_32x32x16_bf16 v[8:23], v[56:59], v[4:7], 0
    ds_read_b128 v[60:63], v81 offset:51200
    v_exp_f32 v31, v31
    v_exp_f32 v32, v32
    v_exp_f32 v33, v33
    v_exp_f32 v34, v34
    v_exp_f32 v35, v35
    s_waitcnt lgkmcnt(2)
    v_smfmac_f32_32x32x32_bf16 v[40:55], v[72:75], v[24:31], v80
    s_mov_b64 exec, s[48:49]
    ds_read_b128 v[64:67], v82 offset:49152
    ds_read_b128 v[68:71], v82 offset:49664
    s_mov_b64 exec, -1
    v_exp_f32 v36, v36
    v_exp_f32 v37, v37
    v_exp_f32 v38, v38
    v_exp_f32 v39, v39
    s_setprio 2
    s_barrier
    v_exp_f32 v8, v8
    v_exp_f32 v9, v9
    s_waitcnt lgkmcnt(3)
    v_smfmac_f32_32x32x32_bf16 v[40:55], v[76:79], v[32:39], v80
    s_add_u32 m0, s54, 0
    s_add_u32 s50, s53, 0
    buffer_load_dwordx4 v2, s[12:15], s50 offen offset:0 lds
    v_exp_f32 v10, v10
    v_exp_f32 v11, v11
    v_exp_f32 v12, v12
    v_exp_f32 v13, v13
    v_exp_f32 v14, v14
    s_waitcnt lgkmcnt(2)
    v_mfma_f32_32x32x16_bf16 v[24:39], v[60:63], v[4:7], 0
    ds_read_b128 v[56:59], v81 offset:53248
    v_exp_f32 v15, v15
    v_exp_f32 v16, v16
    v_exp_f32 v17, v17
    v_exp_f32 v18, v18
    v_exp_f32 v19, v19
    s_waitcnt lgkmcnt(2)
    v_smfmac_f32_32x32x32_bf16 v[40:55], v[64:67], v[8:15], v80
    s_mov_b64 exec, s[48:49]
    ds_read_b128 v[72:75], v82 offset:51200
    ds_read_b128 v[76:79], v82 offset:51712
    s_mov_b64 exec, -1
    buffer_load_dwordx4 v[132:135], v85, s[12:15], s51 offen offset:2048
    v_exp_f32 v20, v20
    v_exp_f32 v21, v21
    v_exp_f32 v22, v22
    v_exp_f32 v23, v23
    v_exp_f32 v24, v24
    v_exp_f32 v25, v25
    s_waitcnt lgkmcnt(3)
    v_smfmac_f32_32x32x32_bf16 v[40:55], v[68:71], v[16:23], v80
    buffer_load_dwordx4 v[136:139], v86, s[12:15], s51 offen offset:2048
    s_add_u32 s51, s51, 4096
    v_exp_f32 v26, v26
    v_exp_f32 v27, v27
    v_exp_f32 v28, v28
    v_exp_f32 v29, v29
    v_exp_f32 v30, v30
    s_waitcnt lgkmcnt(2)
    v_mfma_f32_32x32x16_bf16 v[8:23], v[56:59], v[4:7], 0
    ds_read_b128 v[60:63], v81 offset:55296
    v_exp_f32 v31, v31
    v_exp_f32 v32, v32
    v_exp_f32 v33, v33
    v_exp_f32 v34, v34
    v_exp_f32 v35, v35
    s_waitcnt lgkmcnt(2)
    v_smfmac_f32_32x32x32_bf16 v[40:55], v[72:75], v[24:31], v80
    s_mov_b64 exec, s[48:49]
    ds_read_b128 v[64:67], v82 offset:53248
    ds_read_b128 v[68:71], v82 offset:53760
    s_mov_b64 exec, -1
    v_exp_f32 v36, v36
    v_exp_f32 v37, v37
    v_exp_f32 v38, v38
    v_exp_f32 v39, v39
    v_exp_f32 v8, v8
    v_exp_f32 v9, v9
    s_waitcnt lgkmcnt(3)
    v_smfmac_f32_32x32x32_bf16 v[40:55], v[76:79], v[32:39], v80
    s_lshl_b32 s42, s37, 2
    s_and_b32 s43, s3, 3
    s_add_u32 s42, s42, s43
    s_lshl_b32 s42, s42, 1
    s_lshr_b32 s43, s3, 2
    s_add_u32 s42, s42, s43
    s_mul_i32 s42, s42, 86
    s_mul_i32 s43, s38, 3
    s_add_u32 s42, s42, s43
    s_lshl_b32 s42, s42, 10
    s_add_u32 s42, s42, 12582912
    s_cmp_ge_u32 s38, 29
    s_cselect_b32 s42, 1073741824, s42
    s_cmp_ge_u32 s38, 28
    s_cselect_b32 s43, 1073741824, s42
    s_cmp_lg_u32 s39, 0
    s_cbranch_scc1 L_fast_17
    buffer_store_dwordx4 v[240:243], v2, s[12:15], s42 offen offset:0 sc1
    s_branch L_fdone_18
L_fast_17:
    buffer_store_dwordx4 v[240:243], v2, s[12:15], s42 offen offset:0
L_fdone_18:
    v_exp_f32 v10, v10
    v_exp_f32 v11, v11
    v_exp_f32 v12, v12
    v_exp_f32 v13, v13
    v_exp_f32 v14, v14
    s_waitcnt lgkmcnt(2)
    v_mfma_f32_32x32x16_bf16 v[24:39], v[60:63], v[4:7], 0
    ds_read_b128 v[56:59], v81 offset:57344
    v_exp_f32 v15, v15
    v_exp_f32 v16, v16
    v_exp_f32 v17, v17
    v_exp_f32 v18, v18
    v_exp_f32 v19, v19
    s_waitcnt lgkmcnt(2)
    v_smfmac_f32_32x32x32_bf16 v[40:55], v[64:67], v[8:15], v80
    s_mov_b64 exec, s[48:49]
    ds_read_b128 v[72:75], v82 offset:55296
    ds_read_b128 v[76:79], v82 offset:55808
    s_mov_b64 exec, -1
    buffer_load_dwordx4 v[140:143], v85, s[12:15], s51 offen offset:0
    v_exp_f32 v20, v20
    v_exp_f32 v21, v21
    v_exp_f32 v22, v22
    v_exp_f32 v23, v23
    s_setprio 0
    v_exp_f32 v24, v24
    v_exp_f32 v25, v25
    s_waitcnt lgkmcnt(3)
    v_smfmac_f32_32x32x32_bf16 v[40:55], v[68:71], v[16:23], v80
    buffer_load_dwordx4 v[144:147], v86, s[12:15], s51 offen offset:0
    v_exp_f32 v26, v26
    v_exp_f32 v27, v27
    v_exp_f32 v28, v28
    v_exp_f32 v29, v29
    v_exp_f32 v30, v30
    s_waitcnt lgkmcnt(2)
    v_mfma_f32_32x32x16_bf16 v[8:23], v[56:59], v[4:7], 0
    ds_read_b128 v[60:63], v81 offset:59392
    v_exp_f32 v31, v31
    v_exp_f32 v32, v32
    v_exp_f32 v33, v33
    v_exp_f32 v34, v34
    v_exp_f32 v35, v35
    s_waitcnt lgkmcnt(2)
    v_smfmac_f32_32x32x32_bf16 v[40:55], v[72:75], v[24:31], v80
    s_mov_b64 exec, s[48:49]
    ds_read_b128 v[64:67], v82 offset:57344
    ds_read_b128 v[68:71], v82 offset:57856
    s_mov_b64 exec, -1
    buffer_load_dwordx4 v2, s[12:15], s50 offen offset:1024 lds
    v_exp_f32 v36, v36
    v_exp_f32 v37, v37
    v_exp_f32 v38, v38
    v_exp_f32 v39, v39
    s_setprio 2
    v_exp_f32 v8, v8
    v_exp_f32 v9, v9
    s_waitcnt lgkmcnt(3)
    v_smfmac_f32_32x32x32_bf16 v[40:55], v[76:79], v[32:39], v80
    buffer_load_dwordx4 v[148:151], v85, s[12:15], s51 offen offset:2048
    v_exp_f32 v10, v10
    v_exp_f32 v11, v11
    v_exp_f32 v12, v12
    v_exp_f32 v13, v13
    v_exp_f32 v14, v14
    s_waitcnt lgkmcnt(2)
    v_mfma_f32_32x32x16_bf16 v[24:39], v[60:63], v[4:7], 0
    ds_read_b128 v[56:59], v81 offset:61440
    v_exp_f32 v15, v15
    v_exp_f32 v16, v16
    v_exp_f32 v17, v17
    v_exp_f32 v18, v18
    v_exp_f32 v19, v19
    s_waitcnt lgkmcnt(2)
    v_smfmac_f32_32x32x32_bf16 v[40:55], v[64:67], v[8:15], v80
    s_mov_b64 exec, s[48:49]
    ds_read_b128 v[72:75], v82 offset:59392
    ds_read_b128 v[76:79], v82 offset:59904
    s_mov_b64 exec, -1
    v_exp_f32 v20, v20
    v_exp_f32 v21, v21
    v_exp_f32 v22, v22
    v_exp_f32 v23, v23
    v_exp_f32 v24, v24
    v_exp_f32 v25, v25
    s_waitcnt lgkmcnt(3)
    v_smfmac_f32_32x32x32_bf16 v[40:55], v[68:71], v[16:23], v80
    buffer_load_dwordx4 v[152:155], v86, s[12:15], s51 offen offset:2048
    s_add_u32 s51, s51, 4096
    v_exp_f32 v26, v26
    v_exp_f32 v27, v27
    v_exp_f32 v28, v28
    v_exp_f32 v29, v29
    v_exp_f32 v30, v30
    s_waitcnt lgkmcnt(2)
    v_mfma_f32_32x32x16_bf16 v[8:23], v[56:59], v[4:7], 0
    ds_read_b128 v[60:63], v81 offset:63488
    v_exp_f32 v31, v31
    v_exp_f32 v32, v32
    v_exp_f32 v33, v33
    v_exp_f32 v34, v34
    v_exp_f32 v35, v35
    s_waitcnt lgkmcnt(2)
    v_smfmac_f32_32x32x32_bf16 v[40:55], v[72:75], v[24:31], v80
    s_mov_b64 exec, s[48:49]
    ds_read_b128 v[64:67], v82 offset:61440
    ds_read_b128 v[68:71], v82 offset:61952
    s_mov_b64 exec, -1
    v_exp_f32 v36, v36
    v_exp_f32 v37, v37
    v_exp_f32 v38, v38
    v_exp_f32 v39, v39
    v_exp_f32 v8, v8
    v_exp_f32 v9, v9
    s_waitcnt lgkmcnt(3)
    v_smfmac_f32_32x32x32_bf16 v[40:55], v[76:79], v[32:39], v80
    buffer_load_dwordx4 v[156:159], v85, s[12:15], s52 offen offset:0
    v_exp_f32 v10, v10
    v_exp_f32 v11, v11
    v_exp_f32 v12, v12
    v_exp_f32 v13, v13
    v_exp_f32 v14, v14
    s_waitcnt lgkmcnt(2)
    v_mfma_f32_32x32x16_bf16 v[24:39], v[60:63], v[4:7], 0
    ds_read_b128 v[56:59], v83 offset:0
    v_exp_f32 v15, v15
    v_exp_f32 v16, v16
    v_exp_f32 v17, v17
    v_exp_f32 v18, v18
    v_exp_f32 v19, v19
    s_waitcnt lgkmcnt(2)
    v_smfmac_f32_32x32x32_bf16 v[40:55], v[64:67], v[8:15], v80
    s_mov_b64 exec, s[48:49]
    ds_read_b128 v[72:75], v82 offset:63488
    ds_read_b128 v[76:79], v82 offset:64000
    s_mov_b64 exec, -1
    v_exp_f32 v20, v20
    v_exp_f32 v21, v21
    v_exp_f32 v22, v22
    v_exp_f32 v23, v23
    s_setprio 0
    v_exp_f32 v24, v24
    v_exp_f32 v25, v25
    s_waitcnt lgkmcnt(3)
    v_smfmac_f32_32x32x32_bf16 v[40:55], v[68:71], v[16:23], v80
    v_exp_f32 v26, v26
    v_exp_f32 v27, v27
    v_exp_f32 v28, v28
    v_exp_f32 v29, v29
    v_exp_f32 v30, v30
    s_waitcnt lgkmcnt(2)
    v_mfma_f32_32x32x16_bf16 v[8:23], v[56:59], v[4:7], 0
    ds_read_b128 v[60:63], v83 offset:2048
    v_exp_f32 v31, v31
    v_exp_f32 v32, v32
    v_exp_f32 v33, v33
    v_exp_f32 v34, v34
    v_exp_f32 v35, v35
    s_waitcnt lgkmcnt(2)
    v_smfmac_f32_32x32x32_bf16 v[40:55], v[72:75], v[24:31], v80
    s_mov_b64 exec, s[48:49]
    ds_read_b128 v[64:67], v84 offset:0
    ds_read_b128 v[68:71], v84 offset:512
    s_mov_b64 exec, -1
    buffer_load_dwordx4 v2, s[12:15], s50 offen offset:2048 lds
    v_exp_f32 v36, v36
    v_exp_f32 v37, v37
    v_exp_f32 v38, v38
    v_exp_f32 v39, v39
    s_setprio 2
    v_exp_f32 v8, v8
    v_exp_f32 v9, v9
    s_waitcnt lgkmcnt(3)
    v_smfmac_f32_32x32x32_bf16 v[40:55], v[76:79], v[32:39], v80
    s_lshl_b32 s42, s37, 2
    s_and_b32 s43, s3, 3
    s_add_u32 s42, s42, s43
    s_lshl_b32 s42, s42, 1
    s_lshr_b32 s43, s3, 2
    s_add_u32 s42, s42, s43
    s_mul_i32 s42, s42, 86
    s_mul_i32 s43, s38, 3
    s_add_u32 s42, s42, s43
    s_lshl_b32 s42, s42, 10
    s_add_u32 s42, s42, 12582912
    s_cmp_ge_u32 s38, 29
    s_cselect_b32 s42, 1073741824, s42
    s_cmp_ge_u32 s38, 28
    s_cselect_b32 s43, 1073741824, s42
    s_cmp_lg_u32 s39, 0
    s_cbranch_scc1 L_fast_19
    buffer_store_dwordx4 v[240:243], v2, s[12:15], s42 offen offset:1024 sc1
    s_branch L_fdone_20
L_fast_19:
    buffer_store_dwordx4 v[240:243], v2, s[12:15], s42 offen offset:1024
L_fdone_20:
    v_exp_f32 v10, v10
    v_exp_f32 v11, v11
    v_exp_f32 v12, v12
    v_exp_f32 v13, v13
    v_exp_f32 v14, v14
    s_waitcnt lgkmcnt(2)
    v_mfma_f32_32x32x16_bf16 v[24:39], v[60:63], v[4:7], 0
    ds_read_b128 v[56:59], v83 offset:4096
    v_exp_f32 v15, v15
    v_exp_f32 v16, v16
    v_exp_f32 v17, v17
    v_exp_f32 v18, v18
    v_exp_f32 v19, v19
    s_waitcnt lgkmcnt(2)
    v_smfmac_f32_32x32x32_bf16 v[40:55], v[64:67], v[8:15], v80
    s_mov_b64 exec, s[48:49]
    ds_read_b128 v[72:75], v84 offset:2048
    ds_read_b128 v[76:79], v84 offset:2560
    s_mov_b64 exec, -1
    buffer_load_dwordx4 v[160:163], v86, s[12:15], s52 offen offset:0
    v_exp_f32 v20, v20
    v_exp_f32 v21, v21
    v_exp_f32 v22, v22
    v_exp_f32 v23, v23
    v_exp_f32 v24, v24
    v_exp_f32 v25, v25
    s_waitcnt lgkmcnt(3)
    v_smfmac_f32_32x32x32_bf16 v[40:55], v[68:71], v[16:23], v80
    buffer_load_dwordx4 v[164:167], v85, s[12:15], s52 offen offset:2048
    v_exp_f32 v26, v26
    v_exp_f32 v27, v27
    v_exp_f32 v28, v28
    v_exp_f32 v29, v29
    v_exp_f32 v30, v30
    s_waitcnt lgkmcnt(2)
    v_mfma_f32_32x32x16_bf16 v[8:23], v[56:59], v[4:7], 0
    ds_read_b128 v[60:63], v83 offset:6144
    v_exp_f32 v31, v31
    v_exp_f32 v32, v32
    v_exp_f32 v33, v33
    v_exp_f32 v34, v34
    v_exp_f32 v35, v35
    s_waitcnt lgkmcnt(2)
    v_smfmac_f32_32x32x32_bf16 v[40:55], v[72:75], v[24:31], v80
    s_mov_b64 exec, s[48:49]
    ds_read_b128 v[64:67], v84 offset:4096
    ds_read_b128 v[68:71], v84 offset:4608
    s_mov_b64 exec, -1
    buffer_load_dwordx4 v[168:171], v86, s[12:15], s52 offen offset:2048
    s_add_u32 s52, s52, 4096
    v_exp_f32 v36, v36
    v_exp_f32 v37, v37
    v_exp_f32 v38, v38
    v_exp_f32 v39, v39
    v_exp_f32 v8, v8
    v_exp_f32 v9, v9
    s_waitcnt lgkmcnt(3)
    v_smfmac_f32_32x32x32_bf16 v[40:55], v[76:79], v[32:39], v80
    v_exp_f32 v10, v10
    v_exp_f32 v11, v11
    v_exp_f32 v12, v12
    v_exp_f32 v13, v13
    v_exp_f32 v14, v14
    s_waitcnt lgkmcnt(2)
    v_mfma_f32_32x32x16_bf16 v[24:39], v[60:63], v[4:7], 0
    ds_read_b128 v[56:59], v83 offset:8192
    v_exp_f32 v15, v15
    v_exp_f32 v16, v16
    v_exp_f32 v17, v17
    v_exp_f32 v18, v18
    v_exp_f32 v19, v19
    s_waitcnt lgkmcnt(2)
    v_smfmac_f32_32x32x32_bf16 v[40:55], v[64:67], v[8:15], v80
    s_mov_b64 exec, s[48:49]
    ds_read_b128 v[72:75], v84 offset:6144
    ds_read_b128 v[76:79], v84 offset:6656
    s_mov_b64 exec, -1
    buffer_load_dwordx4 v[172:175], v85, s[12:15], s52 offen offset:0
    v_exp_f32 v20, v20
    v_exp_f32 v21, v21
    v_exp_f32 v22, v22
    v_exp_f32 v23, v23
    s_setprio 0
    v_exp_f32 v24, v24
    v_exp_f32 v25, v25
    s_waitcnt lgkmcnt(3)
    v_smfmac_f32_32x32x32_bf16 v[40:55], v[68:71], v[16:23], v80
    v_exp_f32 v26, v26
    v_exp_f32 v27, v27
    v_exp_f32 v28, v28
    v_exp_f32 v29, v29
    v_exp_f32 v30, v30
    s_waitcnt lgkmcnt(2)
    v_mfma_f32_32x32x16_bf16 v[8:23], v[56:59], v[4:7], 0
    ds_read_b128 v[60:63], v83 offset:10240
    v_exp_f32 v31, v31
    v_exp_f32 v32, v32
    v_exp_f32 v33, v33
    v_exp_f32 v34, v34
    v_exp_f32 v35, v35
    s_waitcnt lgkmcnt(2)
    v_smfmac_f32_32x32x32_bf16 v[40:55], v[72:75], v[24:31], v80
    s_mov_b64 exec, s[48:49]
    ds_read_b128 v[64:67], v84 offset:8192
    ds_read_b128 v[68:71], v84 offset:8704
    s_mov_b64 exec, -1
    buffer_load_dwordx4 v2, s[12:15], s50 offen offset:3072 lds
    v_exp_f32 v36, v36
    v_exp_f32 v37, v37
    v_exp_f32 v38, v38
    v_exp_f32 v39, v39
    s_setprio 2
    v_exp_f32 v8, v8
    v_exp_f32 v9, v9
    s_waitcnt lgkmcnt(3)
    v_smfmac_f32_32x32x32_bf16 v[40:55], v[76:79], v[32:39], v80
    buffer_load_dwordx4 v[176:179], v86, s[12:15], s52 offen offset:0
    v_exp_f32 v10, v10
    v_exp_f32 v11, v11
    v_exp_f32 v12, v12
    v_exp_f32 v13, v13
    v_exp_f32 v14, v14
    s_waitcnt lgkmcnt(2)
    v_mfma_f32_32x32x16_bf16 v[24:39], v[60:63], v[4:7], 0
    ds_read_b128 v[56:59], v83 offset:12288
    v_exp_f32 v15, v15
    v_exp_f32 v16, v16
    v_exp_f32 v17, v17
    v_exp_f32 v18, v18
    v_exp_f32 v19, v19
    s_waitcnt lgkmcnt(2)
    v_smfmac_f32_32x32x32_bf16 v[40:55], v[64:67], v[8:15], v80
    s_mov_b64 exec, s[48:49]
    ds_read_b128 v[72:75], v84 offset:10240
    ds_read_b128 v[76:79], v84 offset:10752
    s_mov_b64 exec, -1
    buffer_load_dwordx4 v[180:183], v85, s[12:15], s52 offen offset:2048
    v_exp_f32 v20, v20
    v_exp_f32 v21, v21
    v_exp_f32 v22, v22
    v_exp_f32 v23, v23
    v_exp_f32 v24, v24
    v_exp_f32 v25, v25
    s_waitcnt lgkmcnt(3)
    v_smfmac_f32_32x32x32_bf16 v[40:55], v[68:71], v[16:23], v80
    v_exp_f32 v26, v26
    v_exp_f32 v27, v27
    v_exp_f32 v28, v28
    v_exp_f32 v29, v29
    v_exp_f32 v30, v30
    s_waitcnt lgkmcnt(2)
    v_mfma_f32_32x32x16_bf16 v[8:23], v[56:59], v[4:7], 0
    ds_read_b128 v[60:63], v83 offset:14336
    v_exp_f32 v31, v31
    v_exp_f32 v32, v32
    v_exp_f32 v33, v33
    v_exp_f32 v34, v34
    v_exp_f32 v35, v35
    s_waitcnt lgkmcnt(2)
    v_smfmac_f32_32x32x32_bf16 v[40:55], v[72:75], v[24:31], v80
    s_mov_b64 exec, s[48:49]
    ds_read_b128 v[64:67], v84 offset:12288
    ds_read_b128 v[68:71], v84 offset:12800
    s_mov_b64 exec, -1
    buffer_load_dwordx4 v[184:187], v86, s[12:15], s52 offen offset:2048
    s_add_u32 s52, s52, 4096
    v_exp_f32 v36, v36
    v_exp_f32 v37, v37
    v_exp_f32 v38, v38
    v_exp_f32 v39, v39
    v_exp_f32 v8, v8
    v_exp_f32 v9, v9
    s_waitcnt lgkmcnt(3)
    v_smfmac_f32_32x32x32_bf16 v[40:55], v[76:79], v[32:39], v80
    s_lshl_b32 s42, s37, 2
    s_and_b32 s43, s3, 3
    s_add_u32 s42, s42, s43
    s_lshl_b32 s42, s42, 1
    s_lshr_b32 s43, s3, 2
    s_add_u32 s42, s42, s43
    s_mul_i32 s42, s42, 86
    s_mul_i32 s43, s38, 3
    s_add_u32 s42, s42, s43
    s_lshl_b32 s42, s42, 10
    s_add_u32 s42, s42, 12582912
    s_cmp_ge_u32 s38, 29
    s_cselect_b32 s42, 1073741824, s42
    s_cmp_ge_u32 s38, 28
    s_cselect_b32 s43, 1073741824, s42
    s_cmp_lg_u32 s39, 0
    s_cbranch_scc1 L_fast_21
    buffer_store_dwordx4 v[240:243], v2, s[12:15], s43 offen offset:2048 sc1
    s_branch L_fdone_22
L_fast_21:
    buffer_store_dwordx4 v[240:243], v2, s[12:15], s43 offen offset:2048
L_fdone_22:
    v_exp_f32 v10, v10
    v_exp_f32 v11, v11
    v_exp_f32 v12, v12
    v_exp_f32 v13, v13
    v_exp_f32 v14, v14
    s_waitcnt lgkmcnt(2)
    v_mfma_f32_32x32x16_bf16 v[24:39], v[60:63], v[4:7], 0
    ds_read_b128 v[56:59], v83 offset:16384
    v_exp_f32 v15, v15
    v_exp_f32 v16, v16
    v_exp_f32 v17, v17
    v_exp_f32 v18, v18
    v_exp_f32 v19, v19
    s_waitcnt lgkmcnt(2)
    v_smfmac_f32_32x32x32_bf16 v[40:55], v[64:67], v[8:15], v80
    s_mov_b64 exec, s[48:49]
    ds_read_b128 v[72:75], v84 offset:14336
    ds_read_b128 v[76:79], v84 offset:14848
    s_mov_b64 exec, -1
    buffer_load_dwordx4 v[188:191], v85, s[12:15], s52 offen offset:0
    v_exp_f32 v20, v20
    v_exp_f32 v21, v21
    v_exp_f32 v22, v22
    v_exp_f32 v23, v23
    s_setprio 0
    v_exp_f32 v24, v24
    v_exp_f32 v25, v25
    s_waitcnt lgkmcnt(3)
    v_smfmac_f32_32x32x32_bf16 v[40:55], v[68:71], v[16:23], v80
    s_add_u32 m0, s54, 4096
    s_add_u32 s50, s53, 4096
    buffer_load_dwordx4 v2, s[12:15], s50 offen offset:0 lds
    v_exp_f32 v26, v26
    v_exp_f32 v27, v27
    v_exp_f32 v28, v28
    v_exp_f32 v29, v29
    v_exp_f32 v30, v30
    s_waitcnt lgkmcnt(2)
    v_mfma_f32_32x32x16_bf16 v[8:23], v[56:59], v[4:7], 0
    ds_read_b128 v[60:63], v83 offset:18432
    v_exp_f32 v31, v31
    v_exp_f32 v32, v32
    v_exp_f32 v33, v33
    v_exp_f32 v34, v34
    v_exp_f32 v35, v35
    s_waitcnt lgkmcnt(2)
    v_smfmac_f32_32x32x32_bf16 v[40:55], v[72:75], v[24:31], v80
    s_mov_b64 exec, s[48:49]
    ds_read_b128 v[64:67], v84 offset:16384
    ds_read_b128 v[68:71], v84 offset:16896
    s_mov_b64 exec, -1
    buffer_load_dwordx4 v[192:195], v86, s[12:15], s52 offen offset:0
    v_exp_f32 v36, v36
    v_exp_f32 v37, v37
    v_exp_f32 v38, v38
    v_exp_f32 v39, v39
    s_setprio 2
    v_exp_f32 v8, v8
    v_exp_f32 v9, v9
    s_waitcnt lgkmcnt(3)
    v_smfmac_f32_32x32x32_bf16 v[40:55], v[76:79], v[32:39], v80
    v_exp_f32 v10, v10
    v_exp_f32 v11, v11
    v_exp_f32 v12, v12
    v_exp_f32 v13, v13
    v_exp_f32 v14, v14
    s_waitcnt lgkmcnt(2)
    v_mfma_f32_32x32x16_bf16 v[24:39], v[60:63], v[4:7], 0
    ds_read_b128 v[56:59], v83 offset:20480
    v_exp_f32 v15, v15
    v_exp_f32 v16, v16
    v_exp_f32 v17, v17
    v_exp_f32 v18, v18
    v_exp_f32 v19, v19
    s_waitcnt lgkmcnt(2)
    v_smfmac_f32_32x32x32_bf16 v[40:55], v[64:67], v[8:15], v80
    s_mov_b64 exec, s[48:49]
    ds_read_b128 v[72:75], v84 offset:18432
    ds_read_b128 v[76:79], v84 offset:18944
    s_mov_b64 exec, -1
    buffer_load_dwordx4 v[196:199], v85, s[12:15], s52 offen offset:2048
    v_exp_f32 v20, v20
    v_exp_f32 v21, v21
    v_exp_f32 v22, v22
    v_exp_f32 v23, v23
    v_exp_f32 v24, v24
    v_exp_f32 v25, v25
    s_waitcnt lgkmcnt(3)
    v_smfmac_f32_32x32x32_bf16 v[40:55], v[68:71], v[16:23], v80
    v_exp_f32 v26, v26
    v_exp_f32 v27, v27
    v_exp_f32 v28, v28
    v_exp_f32 v29, v29
    v_exp_f32 v30, v30
    s_waitcnt lgkmcnt(2)
    v_mfma_f32_32x32x16_bf16 v[8:23], v[56:59], v[4:7], 0
    ds_read_b128 v[60:63], v83 offset:22528
    v_exp_f32 v31, v31
    v_exp_f32 v32, v32
    v_exp_f32 v33, v33
    v_exp_f32 v34, v34
    v_exp_f32 v35, v35
    s_waitcnt lgkmcnt(2)
    v_smfmac_f32_32x32x32_bf16 v[40:55], v[72:75], v[24:31], v80
    s_mov_b64 exec, s[48:49]
    ds_read_b128 v[64:67], v84 offset:20480
    ds_read_b128 v[68:71], v84 offset:20992
    s_mov_b64 exec, -1
    buffer_load_dwordx4 v[200:203], v86, s[12:15], s52 offen offset:2048
    s_add_u32 s52, s52, 4096
    v_exp_f32 v36, v36
    v_exp_f32 v37, v37
    v_exp_f32 v38, v38
    v_exp_f32 v39, v39
    v_exp_f32 v8, v8
    v_exp_f32 v9, v9
    s_waitcnt lgkmcnt(3)
    v_smfmac_f32_32x32x32_bf16 v[40:55], v[76:79], v[32:39], v80
    v_exp_f32 v10, v10
    v_exp_f32 v11, v11
    v_exp_f32 v12, v12
    v_exp_f32 v13, v13
    v_exp_f32 v14, v14
    s_waitcnt lgkmcnt(2)
    v_mfma_f32_32x32x16_bf16 v[24:39], v[60:63], v[4:7], 0
    ds_read_b128 v[56:59], v83 offset:24576
    v_exp_f32 v15, v15
    v_exp_f32 v16, v16
    v_exp_f32 v17, v17
    v_exp_f32 v18, v18
    v_exp_f32 v19, v19
    s_waitcnt lgkmcnt(2)
    v_smfmac_f32_32x32x32_bf16 v[40:55], v[64:67], v[8:15], v80
    s_mov_b64 exec, s[48:49]
    ds_read_b128 v[72:75], v84 offset:22528
    ds_read_b128 v[76:79], v84 offset:23040
    s_mov_b64 exec, -1
    buffer_load_dwordx4 v[204:207], v85, s[12:15], s52 offen offset:0
    v_exp_f32 v20, v20
    v_exp_f32 v21, v21
    v_exp_f32 v22, v22
    v_exp_f32 v23, v23
    s_setprio 0
    v_exp_f32 v24, v24
    v_exp_f32 v25, v25
    s_waitcnt lgkmcnt(3)
    v_smfmac_f32_32x32x32_bf16 v[40:55], v[68:71], v[16:23], v80
    buffer_load_dwordx4 v2, s[12:15], s50 offen offset:1024 lds
    v_exp_f32 v26, v26
    v_exp_f32 v27, v27
    v_exp_f32 v28, v28
    v_exp_f32 v29, v29
    v_exp_f32 v30, v30
    s_waitcnt lgkmcnt(2)
    v_mfma_f32_32x32x16_bf16 v[8:23], v[56:59], v[4:7], 0
    ds_read_b128 v[60:63], v83 offset:26624
    v_exp_f32 v31, v31
    v_exp_f32 v32, v32
    v_exp_f32 v33, v33
    v_exp_f32 v34, v34
    v_exp_f32 v35, v35
    s_waitcnt lgkmcnt(2)
    v_smfmac_f32_32x32x32_bf16 v[40:55], v[72:75], v[24:31], v80
    s_mov_b64 exec, s[48:49]
    ds_read_b128 v[64:67], v84 offset:24576
    ds_read_b128 v[68:71], v84 offset:25088
    s_mov_b64 exec, -1
    buffer_load_dwordx4 v[208:211], v86, s[12:15], s52 offen offset:0
    v_exp_f32 v36, v36
    v_exp_f32 v37, v37
    v_exp_f32 v38, v38
    v_exp_f32 v39, v39
    s_setprio 2
    v_exp_f32 v8, v8
    v_exp_f32 v9, v9
    s_waitcnt lgkmcnt(3)
    v_smfmac_f32_32x32x32_bf16 v[40:55], v[76:79], v[32:39], v80
    v_exp_f32 v10, v10
    v_exp_f32 v11, v11
    v_exp_f32 v12, v12
    v_exp_f32 v13, v13
    v_exp_f32 v14, v14
    s_waitcnt lgkmcnt(2)
    v_mfma_f32_32x32x16_bf16 v[24:39], v[60:63], v[4:7], 0
    ds_read_b128 v[56:59], v83 offset:28672
    v_exp_f32 v15, v15
    v_exp_f32 v16, v16
    v_exp_f32 v17, v17
    v_exp_f32 v18, v18
    v_exp_f32 v19, v19
    s_waitcnt lgkmcnt(2)
    v_smfmac_f32_32x32x32_bf16 v[40:55], v[64:67], v[8:15], v80
    s_mov_b64 exec, s[48:49]
    ds_read_b128 v[72:75], v84 offset:26624
    ds_read_b128 v[76:79], v84 offset:27136
    s_mov_b64 exec, -1
    buffer_load_dwordx4 v[212:215], v85, s[12:15], s52 offen offset:2048
    v_exp_f32 v20, v20
    v_exp_f32 v21, v21
    v_exp_f32 v22, v22
    v_exp_f32 v23, v23
    v_exp_f32 v24, v24
    v_exp_f32 v25, v25
    s_waitcnt lgkmcnt(3)
    v_smfmac_f32_32x32x32_bf16 v[40:55], v[68:71], v[16:23], v80
    v_exp_f32 v26, v26
    v_exp_f32 v27, v27
    v_exp_f32 v28, v28
    v_exp_f32 v29, v29
    v_exp_f32 v30, v30
    s_waitcnt lgkmcnt(2)
    v_mfma_f32_32x32x16_bf16 v[8:23], v[56:59], v[4:7], 0
    ds_read_b128 v[60:63], v83 offset:30720
    v_exp_f32 v31, v31
    v_exp_f32 v32, v32
    v_exp_f32 v33, v33
    v_exp_f32 v34, v34
    v_exp_f32 v35, v35
    s_waitcnt lgkmcnt(2)
    v_smfmac_f32_32x32x32_bf16 v[40:55], v[72:75], v[24:31], v80
    s_mov_b64 exec, s[48:49]
    ds_read_b128 v[64:67], v84 offset:28672
    ds_read_b128 v[68:71], v84 offset:29184
    s_mov_b64 exec, -1
    buffer_load_dwordx4 v[216:219], v86, s[12:15], s52 offen offset:2048
    s_add_u32 s52, s52, 4096
    v_exp_f32 v36, v36
    v_exp_f32 v37, v37
    v_exp_f32 v38, v38
    v_exp_f32 v39, v39
    v_exp_f32 v8, v8
    v_exp_f32 v9, v9
    s_waitcnt lgkmcnt(3)
    v_smfmac_f32_32x32x32_bf16 v[40:55], v[76:79], v[32:39], v80
    v_exp_f32 v10, v10
    v_exp_f32 v11, v11
    v_exp_f32 v12, v12
    v_exp_f32 v13, v13
    v_exp_f32 v14, v14
    s_waitcnt lgkmcnt(2)
    v_mfma_f32_32x32x16_bf16 v[24:39], v[60:63], v[4:7], 0
    ds_read_b128 v[56:59], v83 offset:32768
    v_exp_f32 v15, v15
    v_exp_f32 v16, v16
    v_exp_f32 v17, v17
    v_exp_f32 v18, v18
    v_exp_f32 v19, v19
    s_waitcnt lgkmcnt(2)
    v_smfmac_f32_32x32x32_bf16 v[40:55], v[64:67], v[8:15], v80
    s_mov_b64 exec, s[48:49]
    ds_read_b128 v[72:75], v84 offset:30720
    ds_read_b128 v[76:79], v84 offset:31232
    s_mov_b64 exec, -1
    buffer_load_dwordx4 v[220:223], v85, s[12:15], s52 offen offset:0
    v_exp_f32 v20, v20
    v_exp_f32 v21, v21
    v_exp_f32 v22, v22
    v_exp_f32 v23, v23
    s_setprio 0
    v_exp_f32 v24, v24
    v_exp_f32 v25, v25
    s_waitcnt lgkmcnt(3)
    v_smfmac_f32_32x32x32_bf16 v[40:55], v[68:71], v[16:23], v80
    v_exp_f32 v26, v26
    v_exp_f32 v27, v27
    v_exp_f32 v28, v28
    v_exp_f32 v29, v29
    v_exp_f32 v30, v30
    s_waitcnt lgkmcnt(2)
    v_mfma_f32_32x32x16_bf16 v[8:23], v[56:59], v[4:7], 0
    ds_read_b128 v[60:63], v83 offset:34816
    v_exp_f32 v31, v31
    v_exp_f32 v32, v32
    v_exp_f32 v33, v33
    v_exp_f32 v34, v34
    v_exp_f32 v35, v35
    s_waitcnt lgkmcnt(2)
    v_smfmac_f32_32x32x32_bf16 v[40:55], v[72:75], v[24:31], v80
    s_mov_b64 exec, s[48:49]
    ds_read_b128 v[64:67], v84 offset:32768
    ds_read_b128 v[68:71], v84 offset:33280
    s_mov_b64 exec, -1
    v_exp_f32 v36, v36
    v_exp_f32 v37, v37
    v_exp_f32 v38, v38
    v_exp_f32 v39, v39
    s_setprio 2
    s_waitcnt vmcnt(11)
    s_barrier
    v_exp_f32 v8, v8
    v_exp_f32 v9, v9
    s_waitcnt lgkmcnt(3)
    v_smfmac_f32_32x32x32_bf16 v[40:55], v[76:79], v[32:39], v80
    v_mov_b32 v89, s40
    s_lshl_b32 s43, s37, 5
    s_add_u32 s43, s43, s38
    s_lshl_b32 s43, s43, 2
    s_add_u32 s43, s43, 20480
    s_cmp_eq_u32 s3, 0
    s_cselect_b32 s43, s43, 1073741824
    s_mov_b64 exec, 1
    buffer_store_dword v89, off, s[12:15], s43 sc1
    s_mov_b64 exec, -1
    s_add_u32 m0, s54, 49152
    s_add_u32 s50, s53, 49152
    buffer_load_dwordx4 v2, s[12:15], s50 offen offset:0 lds
    v_exp_f32 v10, v10
    v_exp_f32 v11, v11
    v_exp_f32 v12, v12
    v_exp_f32 v13, v13
    v_exp_f32 v14, v14
    s_waitcnt lgkmcnt(2)
    v_mfma_f32_32x32x16_bf16 v[24:39], v[60:63], v[4:7], 0
    ds_read_b128 v[56:59], v83 offset:36864
    v_exp_f32 v15, v15
    v_exp_f32 v16, v16
    v_exp_f32 v17, v17
    v_exp_f32 v18, v18
    v_exp_f32 v19, v19
    s_waitcnt lgkmcnt(2)
    v_smfmac_f32_32x32x32_bf16 v[40:55], v[64:67], v[8:15], v80
    s_mov_b64 exec, s[48:49]
    ds_read_b128 v[72:75], v84 offset:34816
    ds_read_b128 v[76:79], v84 offset:35328
    s_mov_b64 exec, -1
    buffer_load_dwordx4 v[224:227], v86, s[12:15], s52 offen offset:0
    v_exp_f32 v20, v20
    v_exp_f32 v21, v21
    v_exp_f32 v22, v22
    v_exp_f32 v23, v23
    v_exp_f32 v24, v24
    v_exp_f32 v25, v25
    s_waitcnt lgkmcnt(3)
    v_smfmac_f32_32x32x32_bf16 v[40:55], v[68:71], v[16:23], v80
    v_exp_f32 v26, v26
    v_exp_f32 v27, v27
    v_exp_f32 v28, v28
    v_exp_f32 v29, v29
    v_exp_f32 v30, v30
    s_waitcnt lgkmcnt(2)
    v_mfma_f32_32x32x16_bf16 v[8:23], v[56:59], v[4:7], 0
    ds_read_b128 v[60:63], v83 offset:38912
    v_exp_f32 v31, v31
    v_exp_f32 v32, v32
    v_exp_f32 v33, v33
    v_exp_f32 v34, v34
    v_exp_f32 v35, v35
    s_waitcnt lgkmcnt(2)
    v_smfmac_f32_32x32x32_bf16 v[40:55], v[72:75], v[24:31], v80
    s_mov_b64 exec, s[48:49]
    ds_read_b128 v[64:67], v84 offset:36864
    ds_read_b128 v[68:71], v84 offset:37376
    s_mov_b64 exec, -1
    v_exp_f32 v36, v36
    v_exp_f32 v37, v37
    v_exp_f32 v38, v38
    v_exp_f32 v39, v39
    v_exp_f32 v8, v8
    v_exp_f32 v9, v9
    s_waitcnt lgkmcnt(3)
    v_smfmac_f32_32x32x32_bf16 v[40:55], v[76:79], v[32:39], v80
    buffer_load_dwordx4 v2, s[12:15], s50 offen offset:1024 lds
    v_exp_f32 v10, v10
    v_exp_f32 v11, v11
    v_exp_f32 v12, v12
    v_exp_f32 v13, v13
    v_exp_f32 v14, v14
    s_waitcnt lgkmcnt(2)
    v_mfma_f32_32x32x16_bf16 v[24:39], v[60:63], v[4:7], 0
    ds_read_b128 v[56:59], v83 offset:40960
    v_exp_f32 v15, v15
    v_exp_f32 v16, v16
    v_exp_f32 v17, v17
    v_exp_f32 v18, v18
    v_exp_f32 v19, v19
    s_waitcnt lgkmcnt(2)
    v_smfmac_f32_32x32x32_bf16 v[40:55], v[64:67], v[8:15], v80
    s_mov_b64 exec, s[48:49]
    ds_read_b128 v[72:75], v84 offset:38912
    ds_read_b128 v[76:79], v84 offset:39424
    s_mov_b64 exec, -1
    buffer_load_dwordx4 v[228:231], v85, s[12:15], s52 offen offset:2048
    v_exp_f32 v20, v20
    v_exp_f32 v21, v21
    v_exp_f32 v22, v22
    v_exp_f32 v23, v23
    s_setprio 0
    v_exp_f32 v24, v24
    v_exp_f32 v25, v25
    s_waitcnt lgkmcnt(3)
    v_smfmac_f32_32x32x32_bf16 v[40:55], v[68:71], v[16:23], v80
    v_exp_f32 v26, v26
    v_exp_f32 v27, v27
    v_exp_f32 v28, v28
    v_exp_f32 v29, v29
    v_exp_f32 v30, v30
    s_waitcnt lgkmcnt(2)
    v_mfma_f32_32x32x16_bf16 v[8:23], v[56:59], v[4:7], 0
    ds_read_b128 v[60:63], v83 offset:43008
    v_exp_f32 v31, v31
    v_exp_f32 v32, v32
    v_exp_f32 v33, v33
    v_exp_f32 v34, v34
    v_exp_f32 v35, v35
    s_waitcnt lgkmcnt(2)
    v_smfmac_f32_32x32x32_bf16 v[40:55], v[72:75], v[24:31], v80
    s_mov_b64 exec, s[48:49]
    ds_read_b128 v[64:67], v84 offset:40960
    ds_read_b128 v[68:71], v84 offset:41472
    s_mov_b64 exec, -1
    v_exp_f32 v36, v36
    v_exp_f32 v37, v37
    v_exp_f32 v38, v38
    v_exp_f32 v39, v39
    s_setprio 2
    v_exp_f32 v8, v8
    v_exp_f32 v9, v9
    s_waitcnt lgkmcnt(3)
    v_smfmac_f32_32x32x32_bf16 v[40:55], v[76:79], v[32:39], v80
    buffer_load_dwordx4 v2, s[12:15], s50 offen offset:2048 lds
    v_exp_f32 v10, v10
    v_exp_f32 v11, v11
    v_exp_f32 v12, v12
    v_exp_f32 v13, v13
    v_exp_f32 v14, v14
    s_waitcnt lgkmcnt(2)
    v_mfma_f32_32x32x16_bf16 v[24:39], v[60:63], v[4:7], 0
    ds_read_b128 v[56:59], v83 offset:45056
    v_exp_f32 v15, v15
    v_exp_f32 v16, v16
    v_exp_f32 v17, v17
    v_exp_f32 v18, v18
    v_exp_f32 v19, v19
    s_waitcnt lgkmcnt(2)
    v_smfmac_f32_32x32x32_bf16 v[40:55], v[64:67], v[8:15], v80
    s_mov_b64 exec, s[48:49]
    ds_read_b128 v[72:75], v84 offset:43008
    ds_read_b128 v[76:79], v84 offset:43520
    s_mov_b64 exec, -1
    buffer_load_dwordx4 v[232:235], v86, s[12:15], s52 offen offset:2048
    s_add_u32 s52, s52, 4096
    v_exp_f32 v20, v20
    v_exp_f32 v21, v21
    v_exp_f32 v22, v22
    v_exp_f32 v23, v23
    v_exp_f32 v24, v24
    v_exp_f32 v25, v25
    s_waitcnt lgkmcnt(3)
    v_smfmac_f32_32x32x32_bf16 v[40:55], v[68:71], v[16:23], v80
    v_exp_f32 v26, v26
    v_exp_f32 v27, v27
    v_exp_f32 v28, v28
    v_exp_f32 v29, v29
    v_exp_f32 v30, v30
    s_waitcnt lgkmcnt(2)
    v_mfma_f32_32x32x16_bf16 v[8:23], v[56:59], v[4:7], 0
    ds_read_b128 v[60:63], v83 offset:47104
    v_exp_f32 v31, v31
    v_exp_f32 v32, v32
    v_exp_f32 v33, v33
    v_exp_f32 v34, v34
    v_exp_f32 v35, v35
    s_waitcnt lgkmcnt(2)
    v_smfmac_f32_32x32x32_bf16 v[40:55], v[72:75], v[24:31], v80
    s_mov_b64 exec, s[48:49]
    ds_read_b128 v[64:67], v84 offset:45056
    ds_read_b128 v[68:71], v84 offset:45568
    s_mov_b64 exec, -1
    v_exp_f32 v36, v36
    v_exp_f32 v37, v37
    v_exp_f32 v38, v38
    v_exp_f32 v39, v39
    v_exp_f32 v8, v8
    v_exp_f32 v9, v9
    s_waitcnt lgkmcnt(3)
    v_smfmac_f32_32x32x32_bf16 v[40:55], v[76:79], v[32:39], v80
    buffer_load_dwordx4 v2, s[12:15], s50 offen offset:3072 lds
    v_exp_f32 v10, v10
    v_exp_f32 v11, v11
    v_exp_f32 v12, v12
    v_exp_f32 v13, v13
    v_exp_f32 v14, v14
    s_waitcnt lgkmcnt(2)
    v_mfma_f32_32x32x16_bf16 v[24:39], v[60:63], v[4:7], 0
    ds_read_b128 v[56:59], v83 offset:49152
    v_exp_f32 v15, v15
    v_exp_f32 v16, v16
    v_exp_f32 v17, v17
    v_exp_f32 v18, v18
    v_exp_f32 v19, v19
    s_waitcnt lgkmcnt(2)
    v_smfmac_f32_32x32x32_bf16 v[40:55], v[64:67], v[8:15], v80
    s_mov_b64 exec, s[48:49]
    ds_read_b128 v[72:75], v84 offset:47104
    ds_read_b128 v[76:79], v84 offset:47616
    s_mov_b64 exec, -1
    v_exp_f32 v20, v20
    v_exp_f32 v21, v21
    v_exp_f32 v22, v22
    v_exp_f32 v23, v23
    s_setprio 0
    v_exp_f32 v24, v24
    v_exp_f32 v25, v25
    s_waitcnt lgkmcnt(3)
    v_smfmac_f32_32x32x32_bf16 v[40:55], v[68:71], v[16:23], v80
    buffer_load_dwordx4 v[236:239], v85, s[12:15], s52 offen offset:0
    v_exp_f32 v26, v26
    v_exp_f32 v27, v27
    v_exp_f32 v28, v28
    v_exp_f32 v29, v29
    v_exp_f32 v30, v30
    s_waitcnt lgkmcnt(2)
    v_mfma_f32_32x32x16_bf16 v[8:23], v[56:59], v[4:7], 0
    ds_read_b128 v[60:63], v83 offset:51200
    v_exp_f32 v31, v31
    v_exp_f32 v32, v32
    v_exp_f32 v33, v33
    v_exp_f32 v34, v34
    v_exp_f32 v35, v35
    s_waitcnt lgkmcnt(2)
    v_smfmac_f32_32x32x32_bf16 v[40:55], v[72:75], v[24:31], v80
    s_mov_b64 exec, s[48:49]
    ds_read_b128 v[64:67], v84 offset:49152
    ds_read_b128 v[68:71], v84 offset:49664
    s_mov_b64 exec, -1
    v_exp_f32 v36, v36
    v_exp_f32 v37, v37
    v_exp_f32 v38, v38
    v_exp_f32 v39, v39
    s_setprio 2
    v_exp_f32 v8, v8
    v_exp_f32 v9, v9
    s_waitcnt lgkmcnt(3)
    v_smfmac_f32_32x32x32_bf16 v[40:55], v[76:79], v[32:39], v80
    s_add_u32 m0, s54, 53248
    s_add_u32 s50, s53, 53248
    buffer_load_dwordx4 v2, s[12:15], s50 offen offset:0 lds
    buffer_load_dwordx4 v[244:247], v252, s[4:7], s62 offen
    v_exp_f32 v10, v10
    v_exp_f32 v11, v11
    v_exp_f32 v12, v12
    v_exp_f32 v13, v13
    v_exp_f32 v14, v14
    s_waitcnt lgkmcnt(2)
    v_mfma_f32_32x32x16_bf16 v[24:39], v[60:63], v[4:7], 0
    ds_read_b128 v[56:59], v83 offset:53248
    v_exp_f32 v15, v15
    v_exp_f32 v16, v16
    v_exp_f32 v17, v17
    v_exp_f32 v18, v18
    v_exp_f32 v19, v19
    s_waitcnt lgkmcnt(2)
    v_smfmac_f32_32x32x32_bf16 v[40:55], v[64:67], v[8:15], v80
    s_mov_b64 exec, s[48:49]
    ds_read_b128 v[72:75], v84 offset:51200
    ds_read_b128 v[76:79], v84 offset:51712
    s_mov_b64 exec, -1
    v_exp_f32 v20, v20
    v_exp_f32 v21, v21
    v_exp_f32 v22, v22
    v_exp_f32 v23, v23
    v_exp_f32 v24, v24
    v_exp_f32 v25, v25
    s_waitcnt lgkmcnt(3)
    v_smfmac_f32_32x32x32_bf16 v[40:55], v[68:71], v[16:23], v80
    v_exp_f32 v26, v26
    v_exp_f32 v27, v27
    v_exp_f32 v28, v28
    v_exp_f32 v29, v29
    v_exp_f32 v30, v30
    s_waitcnt lgkmcnt(2)
    v_mfma_f32_32x32x16_bf16 v[8:23], v[56:59], v[4:7], 0
    ds_read_b128 v[60:63], v83 offset:55296
    v_exp_f32 v31, v31
    v_exp_f32 v32, v32
    v_exp_f32 v33, v33
    v_exp_f32 v34, v34
    v_exp_f32 v35, v35
    s_waitcnt lgkmcnt(2)
    v_smfmac_f32_32x32x32_bf16 v[40:55], v[72:75], v[24:31], v80
    s_mov_b64 exec, s[48:49]
    ds_read_b128 v[64:67], v84 offset:53248
    ds_read_b128 v[68:71], v84 offset:53760
    s_mov_b64 exec, -1
    buffer_load_dwordx4 v[240:243], v86, s[12:15], s52 offen offset:0
    v_exp_f32 v36, v36
    v_exp_f32 v37, v37
    v_exp_f32 v38, v38
    v_exp_f32 v39, v39
    v_exp_f32 v8, v8
    v_exp_f32 v9, v9
    s_waitcnt lgkmcnt(3)
    v_smfmac_f32_32x32x32_bf16 v[40:55], v[76:79], v[32:39], v80
    buffer_load_dwordx4 v2, s[12:15], s50 offen offset:1024 lds
    buffer_load_dword v89, v91, s[12:15], 0 offen sc1
    v_exp_f32 v10, v10
    v_exp_f32 v11, v11
    v_exp_f32 v12, v12
    v_exp_f32 v13, v13
    v_exp_f32 v14, v14
    s_waitcnt lgkmcnt(2)
    v_mfma_f32_32x32x16_bf16 v[24:39], v[60:63], v[4:7], 0
    ds_read_b128 v[56:59], v83 offset:57344
    v_exp_f32 v15, v15
    v_exp_f32 v16, v16
    v_exp_f32 v17, v17
    v_exp_f32 v18, v18
    v_exp_f32 v19, v19
    s_waitcnt lgkmcnt(2)
    v_smfmac_f32_32x32x32_bf16 v[40:55], v[64:67], v[8:15], v80
    s_mov_b64 exec, s[48:49]
    ds_read_b128 v[72:75], v84 offset:55296
    ds_read_b128 v[76:79], v84 offset:55808
    s_mov_b64 exec, -1
    v_exp_f32 v20, v20
    v_exp_f32 v21, v21
    v_exp_f32 v22, v22
    v_exp_f32 v23, v23
    s_setprio 0
    v_exp_f32 v24, v24
    v_exp_f32 v25, v25
    s_waitcnt lgkmcnt(3)
    v_smfmac_f32_32x32x32_bf16 v[40:55], v[68:71], v[16:23], v80
    v_exp_f32 v26, v26
    v_exp_f32 v27, v27
    v_exp_f32 v28, v28
    v_exp_f32 v29, v29
    v_exp_f32 v30, v30
    s_waitcnt lgkmcnt(2)
    v_mfma_f32_32x32x16_bf16 v[8:23], v[56:59], v[4:7], 0
    ds_read_b128 v[60:63], v83 offset:59392
    v_exp_f32 v31, v31
    v_exp_f32 v32, v32
    v_exp_f32 v33, v33
    v_exp_f32 v34, v34
    v_exp_f32 v35, v35
    s_waitcnt lgkmcnt(2)
    v_smfmac_f32_32x32x32_bf16 v[40:55], v[72:75], v[24:31], v80
    s_mov_b64 exec, s[48:49]
    ds_read_b128 v[64:67], v84 offset:57344
    ds_read_b128 v[68:71], v84 offset:57856
    s_mov_b64 exec, -1
    v_exp_f32 v36, v36
    v_exp_f32 v37, v37
    v_exp_f32 v38, v38
    v_exp_f32 v39, v39
    s_setprio 2
    v_exp_f32 v8, v8
    v_exp_f32 v9, v9
    s_waitcnt lgkmcnt(3)
    v_smfmac_f32_32x32x32_bf16 v[40:55], v[76:79], v[32:39], v80
    v_exp_f32 v10, v10
    v_exp_f32 v11, v11
    v_exp_f32 v12, v12
    v_exp_f32 v13, v13
    v_exp_f32 v14, v14
    s_waitcnt lgkmcnt(2)
    v_mfma_f32_32x32x16_bf16 v[24:39], v[60:63], v[4:7], 0
    ds_read_b128 v[56:59], v83 offset:61440
    v_exp_f32 v15, v15
    v_exp_f32 v16, v16
    v_exp_f32 v17, v17
    v_exp_f32 v18, v18
    v_exp_f32 v19, v19
    s_waitcnt lgkmcnt(2)
    v_smfmac_f32_32x32x32_bf16 v[40:55], v[64:67], v[8:15], v80
    s_mov_b64 exec, s[48:49]
    ds_read_b128 v[72:75], v84 offset:59392
    ds_read_b128 v[76:79], v84 offset:59904
    s_mov_b64 exec, -1
    v_exp_f32 v20, v20
    v_exp_f32 v21, v21
    v_exp_f32 v22, v22
    v_exp_f32 v23, v23
    v_exp_f32 v24, v24
    v_exp_f32 v25, v25
    s_waitcnt lgkmcnt(3)
    v_smfmac_f32_32x32x32_bf16 v[40:55], v[68:71], v[16:23], v80
    v_exp_f32 v26, v26
    v_exp_f32 v27, v27
    v_exp_f32 v28, v28
    v_exp_f32 v29, v29
    v_exp_f32 v30, v30
    s_waitcnt lgkmcnt(2)
    v_mfma_f32_32x32x16_bf16 v[8:23], v[56:59], v[4:7], 0
    ds_read_b128 v[60:63], v83 offset:63488
    v_exp_f32 v31, v31
    v_exp_f32 v32, v32
    v_exp_f32 v33, v33
    v_exp_f32 v34, v34
    v_exp_f32 v35, v35
    s_waitcnt lgkmcnt(2)
    v_smfmac_f32_32x32x32_bf16 v[40:55], v[72:75], v[24:31], v80
    s_mov_b64 exec, s[48:49]
    ds_read_b128 v[64:67], v84 offset:61440
    ds_read_b128 v[68:71], v84 offset:61952
    s_mov_b64 exec, -1
    v_exp_f32 v36, v36
    v_exp_f32 v37, v37
    v_exp_f32 v38, v38
    v_exp_f32 v39, v39
    v_exp_f32 v8, v8
    v_exp_f32 v9, v9
    s_waitcnt lgkmcnt(3)
    v_smfmac_f32_32x32x32_bf16 v[40:55], v[76:79], v[32:39], v80
    v_exp_f32 v10, v10
    v_exp_f32 v11, v11
    v_exp_f32 v12, v12
    v_exp_f32 v13, v13
    v_exp_f32 v14, v14
    s_waitcnt lgkmcnt(2)
    v_mfma_f32_32x32x16_bf16 v[24:39], v[60:63], v[4:7], 0
    v_exp_f32 v15, v15
    v_exp_f32 v16, v16
    v_exp_f32 v17, v17
    v_exp_f32 v18, v18
    v_exp_f32 v19, v19
    s_waitcnt lgkmcnt(1)
    v_smfmac_f32_32x32x32_bf16 v[40:55], v[64:67], v[8:15], v80
    s_mov_b64 exec, s[48:49]
    ds_read_b128 v[72:75], v84 offset:63488
    ds_read_b128 v[76:79], v84 offset:64000
    s_mov_b64 exec, -1
    v_exp_f32 v20, v20
    v_exp_f32 v21, v21
    v_exp_f32 v22, v22
    v_exp_f32 v23, v23
    s_setprio 0
    v_exp_f32 v24, v24
    v_exp_f32 v25, v25
    s_waitcnt lgkmcnt(2)
    v_smfmac_f32_32x32x32_bf16 v[40:55], v[68:71], v[16:23], v80
    v_exp_f32 v26, v26
    v_exp_f32 v27, v27
    v_exp_f32 v28, v28
    v_exp_f32 v29, v29
    v_exp_f32 v30, v30
    v_exp_f32 v31, v31
    v_exp_f32 v32, v32
    v_exp_f32 v33, v33
    v_exp_f32 v34, v34
    v_exp_f32 v35, v35
    s_waitcnt lgkmcnt(1)
    v_smfmac_f32_32x32x32_bf16 v[40:55], v[72:75], v[24:31], v80
    v_exp_f32 v36, v36
    v_exp_f32 v37, v37
    v_exp_f32 v38, v38
    v_exp_f32 v39, v39
    s_waitcnt lgkmcnt(0)
    s_nop 0
    v_smfmac_f32_32x32x32_bf16 v[40:55], v[76:79], v[32:39], v80
    s_setprio 0
    s_waitcnt vmcnt(0) lgkmcnt(0)
    s_mov_b32 s41, 131072
    s_branch L_cchk_25
L_cpoll_23:
    buffer_load_dword v89, v91, s[12:15], 0 offen sc1
    s_waitcnt vmcnt(0)
L_cchk_25:
    v_xor_b32 v88, s40, v89
    v_lshlrev_b32 v87, 4, v88
    v_cmp_ne_u32 vcc, 0, v87
    s_cbranch_vccz L_cdone_24
    s_sub_u32 s41, s41, 1
    s_cbranch_scc0 L_cpoll_23
L_cdone_24:
    v_cmp_ne_u32 vcc, 0, v88
    s_cmp_eq_u32 vcc_lo, 0
    s_cselect_b32 s39, 1, 0
    s_nop 15
    s_nop 3
    s_branch L_attn_done
L_helper:
    s_sub_u32 s100, s3, 4
    s_mul_i32 s95, s37, 0
    s_add_u32 s95, s95, s38
    v_lshrrev_b32 v9, 3, v1
    v_lshrrev_b32 v10, 4, v1
    v_and_b32 v11, 7, v1
    v_xor_b32 v12, v11, v10
    v_lshlrev_b32 v12, 4, v12
    v_lshl_add_u32 v4, v9, 10, v12
    v_xor_b32 v5, 64, v4
    v_and_b32 v10, 1, v10
    v_lshlrev_b32 v10, 2, v10
    v_xor_b32 v11, v11, v10
    v_mul_u32_u24 v6, 3072, v9
    v_lshl_add_u32 v6, v11, 4, v6
    s_lshl_b32 s96, s38, 2
    s_add_u32 s96, s96, s100
    s_lshl_b32 s96, s96, 14
    s_mul_i32 s97, s100, 49152
    s_lshl_b32 s98, s37, 7
    s_add_u32 s97, s97, s98
    s_lshl_b32 s98, s100, 11
    s_add_u32 s98, s98, 98304
    s_mul_i32 s99, s100, 6144
    s_waitcnt lgkmcnt(0)
    s_load_dword s36, s[62:63], 0
    s_mov_b32 s4, s40
    s_mov_b32 s5, s41
    s_mov_b32 s6, 0x200000
    s_mov_b32 s7, 0x00020000
    s_mov_b32 s8, s42
    s_mov_b32 s9, s43
    s_mov_b32 s10, 0x180000
    s_mov_b32 s11, 0x00020000
    s_add_u32 s43, s95, 0
    s_and_b32 s43, s43, 7
    s_lshl_b32 s43, s43, 7
    s_add_u32 s43, s43, s96
    s_add_u32 m0, s98, 0
    s_add_u32 s42, s43, 8192
    buffer_load_dwordx4 v4, s[4:7], s43 offen lds
    s_add_u32 m0, s98, 1024
    s_nop 0
    buffer_load_dwordx4 v5, s[4:7], s42 offen lds
    s_add_u32 s43, s95, 0
    s_and_b32 s43, s43, 7
    s_mul_i32 s43, s43, 196608
    s_add_u32 m0, s99, 0
    s_add_u32 s43, s43, s97
    s_add_u32 s42, s43, 24576
    buffer_load_dwordx4 v6, s[8:11], s43 offen offset:0 lds
    buffer_load_dwordx4 v6, s[8:11], s43 offen offset:1024 lds
    buffer_load_dwordx4 v6, s[8:11], s43 offen offset:2048 lds
    s_add_u32 m0, s99, 3072
    s_nop 0
    buffer_load_dwordx4 v6, s[8:11], s42 offen offset:0 lds
    buffer_load_dwordx4 v6, s[8:11], s42 offen offset:1024 lds
    buffer_load_dwordx4 v6, s[8:11], s42 offen offset:2048 lds
    s_add_u32 s43, s95, 1
    s_and_b32 s43, s43, 7
    s_lshl_b32 s43, s43, 7
    s_add_u32 s43, s43, s96
    s_add_u32 m0, s98, 8192
    s_add_u32 s42, s43, 8192
    buffer_load_dwordx4 v4, s[4:7], s43 offen lds
    s_add_u32 m0, s98, 9216
    s_nop 0
    buffer_load_dwordx4 v5, s[4:7], s42 offen lds
    s_add_u32 s43, s95, 1
    s_and_b32 s43, s43, 7
    s_mul_i32 s43, s43, 196608
    s_add_u32 m0, s99, 24576
    s_add_u32 s43, s43, s97
    s_add_u32 s42, s43, 24576
    buffer_load_dwordx4 v6, s[8:11], s43 offen offset:0 lds
    buffer_load_dwordx4 v6, s[8:11], s43 offen offset:1024 lds
    buffer_load_dwordx4 v6, s[8:11], s43 offen offset:2048 lds
    s_add_u32 m0, s99, 27648
    s_nop 0
    buffer_load_dwordx4 v6, s[8:11], s42 offen offset:0 lds
    buffer_load_dwordx4 v6, s[8:11], s42 offen offset:1024 lds
    buffer_load_dwordx4 v6, s[8:11], s42 offen offset:2048 lds
    s_add_u32 s43, s95, 2
    s_and_b32 s43, s43, 7
    s_lshl_b32 s43, s43, 7
    s_add_u32 s43, s43, s96
    s_add_u32 m0, s98, 16384
    s_add_u32 s42, s43, 8192
    buffer_load_dwordx4 v4, s[4:7], s43 offen lds
    s_add_u32 m0, s98, 17408
    s_nop 0
    buffer_load_dwordx4 v5, s[4:7], s42 offen lds
    s_mov_b32 s12, s62
    s_mov_b32 s13, s63
    s_mov_b32 s14, 0x1800000
    s_mov_b32 s15, 0x00020000
    s_mov_b32 s16, s44
    s_mov_b32 s17, s45
    s_mov_b32 s18, 0x80000
    s_mov_b32 s19, 0x00020000
    s_mov_b32 s20, s48
    s_mov_b32 s21, s49
    s_mov_b32 s22, 0x158000
    s_mov_b32 s23, 0x00020000
    s_mov_b32 s24, s50
    s_mov_b32 s25, s51
    s_mov_b32 s26, 0x158000
    s_mov_b32 s27, 0x00020000
    s_mov_b32 s28, s52
    s_mov_b32 s29, s53
    s_mov_b32 s30, 0x158000
    s_mov_b32 s31, 0x00020000
    s_mov_b32 s32, s54
    s_mov_b32 s33, s55
    s_mov_b32 s34, 0x200000
    s_mov_b32 s35, 0x00020000
    v_and_b32 v9, 15, v1
    v_bfe_u32 v10, v1, 1, 3
    v_lshrrev_b32 v11, 4, v1
    v_xor_b32 v10, v10, v11
    v_lshlrev_b32 v10, 4, v10
    v_lshl_add_u32 v10, v9, 7, v10
    v_add_u32 v7, s98, v10
    v_xor_b32 v8, 64, v7
    v_mov_b32 v12, 0x3f803f80
    v_mov_b32 v13, 0x3f803f80
    v_mov_b32 v14, 0x3f803f80
    v_mov_b32 v15, 0x3f803f80
    s_lshl_b32 s44, s100, 6
    s_add_u32 s44, s44, 163328
    v_lshl_add_u32 v3, v9, 2, s44
    s_waitcnt lgkmcnt(0)
    s_add_u32 s63, s36, 1
    s_mul_i32 s36, s63, 0x9E3779B1
    s_getreg_b32 s40, hwreg(HW_REG_XCC_ID)
    s_lshl_b32 s40, s40, 28
    s_and_b32 s42, s36, 0x0fffffff
    s_or_b32 s40, s40, s42
    s_waitcnt vmcnt(10)
    s_barrier
    ds_read_b128 v[48:51], v7 offset:0
    ds_read_b128 v[52:55], v8 offset:0
    s_add_u32 s43, s95, 2
    s_and_b32 s43, s43, 7
    s_mul_i32 s43, s43, 196608
    s_add_u32 m0, s99, 49152
    s_add_u32 s43, s43, s97
    s_add_u32 s42, s43, 24576
    buffer_load_dwordx4 v6, s[8:11], s43 offen offset:0 lds
    buffer_load_dwordx4 v6, s[8:11], s43 offen offset:1024 lds
    buffer_load_dwordx4 v6, s[8:11], s43 offen offset:2048 lds
    s_add_u32 m0, s99, 52224
    s_nop 0
    buffer_load_dwordx4 v6, s[8:11], s42 offen offset:0 lds
    buffer_load_dwordx4 v6, s[8:11], s42 offen offset:1024 lds
    buffer_load_dwordx4 v6, s[8:11], s42 offen offset:2048 lds
    s_add_u32 s43, s95, 3
    s_and_b32 s43, s43, 7
    s_lshl_b32 s43, s43, 7
    s_add_u32 s43, s43, s96
    s_add_u32 m0, s98, 24576
    s_add_u32 s42, s43, 8192
    buffer_load_dwordx4 v4, s[4:7], s43 offen lds
    s_add_u32 m0, s98, 25600
    s_nop 0
    buffer_load_dwordx4 v5, s[4:7], s42 offen lds
    s_waitcnt vmcnt(10)
    s_barrier
    ds_read_b128 v[56:59], v7 offset:8192
    ds_read_b128 v[60:63], v8 offset:8192
    s_add_u32 s43, s95, 3
    s_and_b32 s43, s43, 7
    s_mul_i32 s43, s43, 196608
    s_add_u32 m0, s99, 73728
    s_add_u32 s43, s43, s97
    s_add_u32 s42, s43, 24576
    buffer_load_dwordx4 v6, s[8:11], s43 offen offset:0 lds
    buffer_load_dwordx4 v6, s[8:11], s43 offen offset:1024 lds
    buffer_load_dwordx4 v6, s[8:11], s43 offen offset:2048 lds
    s_add_u32 m0, s99, 76800
    s_nop 0
    buffer_load_dwordx4 v6, s[8:11], s42 offen offset:0 lds
    buffer_load_dwordx4 v6, s[8:11], s42 offen offset:1024 lds
    buffer_load_dwordx4 v6, s[8:11], s42 offen offset:2048 lds
    s_add_u32 s43, s95, 4
    s_and_b32 s43, s43, 7
    s_lshl_b32 s43, s43, 7
    s_add_u32 s43, s43, s96
    s_add_u32 m0, s98, 32768
    s_add_u32 s42, s43, 8192
    buffer_load_dwordx4 v4, s[4:7], s43 offen lds
    s_add_u32 m0, s98, 33792
    s_nop 0
    buffer_load_dwordx4 v5, s[4:7], s42 offen lds
    s_waitcnt vmcnt(10)
    s_barrier
    ds_read_b128 v[64:67], v7 offset:16384
    ds_read_b128 v[68:71], v8 offset:16384
    s_add_u32 s43, s95, 4
    s_and_b32 s43, s43, 7
    s_mul_i32 s43, s43, 196608
    s_add_u32 m0, s99, 0
    s_add_u32 s43, s43, s97
    s_add_u32 s42, s43, 24576
    buffer_load_dwordx4 v6, s[8:11], s43 offen offset:0 lds
    buffer_load_dwordx4 v6, s[8:11], s43 offen offset:1024 lds
    buffer_load_dwordx4 v6, s[8:11], s43 offen offset:2048 lds
    s_add_u32 m0, s99, 3072
    s_nop 0
    buffer_load_dwordx4 v6, s[8:11], s42 offen offset:0 lds
    buffer_load_dwordx4 v6, s[8:11], s42 offen offset:1024 lds
    buffer_load_dwordx4 v6, s[8:11], s42 offen offset:2048 lds
    s_waitcnt lgkmcnt(4)
    s_add_u32 s43, s95, 5
    s_and_b32 s43, s43, 7
    s_lshl_b32 s43, s43, 7
    s_add_u32 s43, s43, s96
    s_add_u32 m0, s98, 0
    s_add_u32 s42, s43, 8192
    buffer_load_dwordx4 v4, s[4:7], s43 offen lds
    s_add_u32 m0, s98, 1024
    s_nop 0
    buffer_load_dwordx4 v5, s[4:7], s42 offen lds
    s_waitcnt vmcnt(10)
    s_barrier
    ds_read_b128 v[72:75], v7 offset:24576
    ds_read_b128 v[76:79], v8 offset:24576
    s_waitcnt vmcnt(8)
    ds_read_b128 v[80:83], v7 offset:32768
    ds_read_b128 v[84:87], v8 offset:32768
    s_add_u32 s43, s95, 5
    s_and_b32 s43, s43, 7
    s_mul_i32 s43, s43, 196608
    s_add_u32 m0, s99, 24576
    s_add_u32 s43, s43, s97
    s_add_u32 s42, s43, 24576
    buffer_load_dwordx4 v6, s[8:11], s43 offen offset:0 lds
    buffer_load_dwordx4 v6, s[8:11], s43 offen offset:1024 lds
    buffer_load_dwordx4 v6, s[8:11], s43 offen offset:2048 lds
    s_add_u32 m0, s99, 27648
    s_nop 0
    buffer_load_dwordx4 v6, s[8:11], s42 offen offset:0 lds
    buffer_load_dwordx4 v6, s[8:11], s42 offen offset:1024 lds
    buffer_load_dwordx4 v6, s[8:11], s42 offen offset:2048 lds
    s_waitcnt lgkmcnt(6)
    s_add_u32 s43, s95, 6
    s_and_b32 s43, s43, 7
    s_lshl_b32 s43, s43, 7
    s_add_u32 s43, s43, s96
    s_add_u32 m0, s98, 8192
    s_add_u32 s42, s43, 8192
    buffer_load_dwordx4 v4, s[4:7], s43 offen lds
    s_add_u32 m0, s98, 9216
    s_nop 0
    buffer_load_dwordx4 v5, s[4:7], s42 offen lds
    v_mfma_f32_16x16x32_bf16 v[32:35], v[12:15], v[48:51], 0
    v_mfma_f32_16x16x32_bf16 v[36:39], v[48:51], v[48:51], 0
    v_mfma_f32_16x16x32_bf16 v[32:35], v[12:15], v[52:55], v[32:35]
    v_mfma_f32_16x16x32_bf16 v[36:39], v[52:55], v[52:55], v[36:39]
    v_mfma_f32_16x16x32_bf16 v[32:35], v[12:15], v[56:59], v[32:35]
    v_mfma_f32_16x16x32_bf16 v[36:39], v[56:59], v[56:59], v[36:39]
    v_mfma_f32_16x16x32_bf16 v[32:35], v[12:15], v[60:63], v[32:35]
    v_mfma_f32_16x16x32_bf16 v[36:39], v[60:63], v[60:63], v[36:39]
    s_waitcnt lgkmcnt(5)
    v_mfma_f32_16x16x32_bf16 v[32:35], v[12:15], v[64:67], v[32:35]
    v_mfma_f32_16x16x32_bf16 v[36:39], v[64:67], v[64:67], v[36:39]
    s_waitcnt lgkmcnt(4)
    v_mfma_f32_16x16x32_bf16 v[32:35], v[12:15], v[68:71], v[32:35]
    v_mfma_f32_16x16x32_bf16 v[36:39], v[68:71], v[68:71], v[36:39]
    s_waitcnt vmcnt(10)
    s_barrier
    s_waitcnt vmcnt(8)
    ds_read_b128 v[88:91], v7 offset:0
    ds_read_b128 v[92:95], v8 offset:0
    s_add_u32 s43, s95, 6
    s_and_b32 s43, s43, 7
    s_mul_i32 s43, s43, 196608
    s_add_u32 m0, s99, 49152
    s_add_u32 s43, s43, s97
    s_add_u32 s42, s43, 24576
    buffer_load_dwordx4 v6, s[8:11], s43 offen offset:0 lds
    buffer_load_dwordx4 v6, s[8:11], s43 offen offset:1024 lds
    buffer_load_dwordx4 v6, s[8:11], s43 offen offset:2048 lds
    s_add_u32 m0, s99, 52224
    s_nop 0
    buffer_load_dwordx4 v6, s[8:11], s42 offen offset:0 lds
    buffer_load_dwordx4 v6, s[8:11], s42 offen offset:1024 lds
    buffer_load_dwordx4 v6, s[8:11], s42 offen offset:2048 lds
    s_add_u32 s43, s95, 7
    s_and_b32 s43, s43, 7
    s_lshl_b32 s43, s43, 7
    s_add_u32 s43, s43, s96
    s_add_u32 m0, s98, 16384
    s_add_u32 s42, s43, 8192
    buffer_load_dwordx4 v4, s[4:7], s43 offen lds
    s_add_u32 m0, s98, 17408
    s_nop 0
    buffer_load_dwordx4 v5, s[4:7], s42 offen lds
    s_waitcnt lgkmcnt(5)
    v_mfma_f32_16x16x32_bf16 v[32:35], v[12:15], v[72:75], v[32:35]
    v_mfma_f32_16x16x32_bf16 v[36:39], v[72:75], v[72:75], v[36:39]
    s_waitcnt lgkmcnt(4)
    v_mfma_f32_16x16x32_bf16 v[32:35], v[12:15], v[76:79], v[32:35]
    v_mfma_f32_16x16x32_bf16 v[36:39], v[76:79], v[76:79], v[36:39]
    s_waitcnt lgkmcnt(3)
    v_mfma_f32_16x16x32_bf16 v[32:35], v[12:15], v[80:83], v[32:35]
    v_mfma_f32_16x16x32_bf16 v[36:39], v[80:83], v[80:83], v[36:39]
    s_waitcnt lgkmcnt(2)
    v_mfma_f32_16x16x32_bf16 v[32:35], v[12:15], v[84:87], v[32:35]
    v_mfma_f32_16x16x32_bf16 v[36:39], v[84:87], v[84:87], v[36:39]
    s_waitcnt vmcnt(10)
    s_barrier
    s_waitcnt vmcnt(8)
    ds_read_b128 v[96:99], v7 offset:8192
    ds_read_b128 v[100:103], v8 offset:8192
    s_add_u32 s43, s95, 7
    s_and_b32 s43, s43, 7
    s_mul_i32 s43, s43, 196608
    s_add_u32 m0, s99, 73728
    s_add_u32 s43, s43, s97
    s_add_u32 s42, s43, 24576
    buffer_load_dwordx4 v6, s[8:11], s43 offen offset:0 lds
    buffer_load_dwordx4 v6, s[8:11], s43 offen offset:1024 lds
    buffer_load_dwordx4 v6, s[8:11], s43 offen offset:2048 lds
    s_add_u32 m0, s99, 76800
    s_nop 0
    buffer_load_dwordx4 v6, s[8:11], s42 offen offset:0 lds
    buffer_load_dwordx4 v6, s[8:11], s42 offen offset:1024 lds
    buffer_load_dwordx4 v6, s[8:11], s42 offen offset:2048 lds
    s_lshl_b32 s45, s100, 12
    s_add_u32 s45, s45, 139264
    s_cmp_ge_u32 s2, 176
    s_cbranch_scc1 L_pw2_26
    v_lshrrev_b32 v156, 2, v1
    v_mul_u32_u24 v156, 2752, v156
    v_and_b32 v158, 3, v1
    v_lshl_add_u32 v156, v158, 4, v156
    s_lshr_b32 s43, s2, 4
    s_lshl_b32 s43, s43, 2
    s_add_u32 s43, s43, s100
    s_and_b32 s42, s2, 15
    s_mul_i32 s46, s42, 88064
    s_lshl_b32 s47, s43, 6
    s_add_u32 s46, s46, s47
    s_mov_b32 s47, s46
    s_add_u32 s48, s46, 44032
    s_add_u32 s49, s46, 44032
    s_branch L_pdn_27
L_pw2_26:
    v_lshrrev_b32 v156, 3, v1
    v_and_b32 v158, 7, v1
    v_lshlrev_b32 v158, 4, v158
    v_lshl_add_u32 v156, v156, 10, v158
    s_mov_b32 s20, s28
    s_mov_b32 s24, s28
    s_mov_b32 s21, s29
    s_mov_b32 s25, s29
    s_mov_b32 s22, s30
    s_mov_b32 s26, s30
    s_sub_u32 s43, s2, 176
    s_lshl_b32 s46, s43, 14
    s_lshl_b32 s47, s100, 8
    s_add_u32 s46, s46, s47
    s_add_u32 s47, s46, 8192
    s_add_u32 s48, s46, 128
    s_add_u32 s49, s47, 128
L_pdn_27:
    s_add_u32 m0, s45, 0
    s_nop 0
    buffer_load_dwordx4 v156, s[20:23], s46 offen lds
    s_add_u32 m0, s45, 1024
    s_nop 0
    buffer_load_dwordx4 v156, s[24:27], s47 offen lds
    s_add_u32 m0, s45, 2048
    s_nop 0
    buffer_load_dwordx4 v156, s[20:23], s48 offen lds
    s_add_u32 m0, s45, 3072
    s_nop 0
    buffer_load_dwordx4 v156, s[24:27], s49 offen lds
    s_lshl_b32 s47, s100, 8
    s_add_u32 s47, s47, s2
    s_cmp_ge_u32 s47, 320
    s_cbranch_scc1 L_nor2_28
    v_lshrrev_b32 v157, 3, v1
    v_and_b32 v158, 7, v1
    v_lshlrev_b32 v158, 4, v158
    v_lshl_add_u32 v157, v157, 10, v158
    s_cmp_eq_u32 s100, 0
    s_cselect_b32 s16, s16, s28
    s_cselect_b32 s17, s17, s29
    s_cselect_b32 s18, s18, s30
    s_cselect_b32 s46, 0, 80
    s_add_u32 s46, s46, s38
    s_lshl_b32 s46, s46, 14
    s_lshl_b32 s47, s37, 7
    s_add_u32 s46, s46, s47
    s_add_u32 s47, s46, 8192
    s_lshl_b32 s45, s100, 11
    s_add_u32 m0, s45, 155648
    s_nop 0
    buffer_load_dwordx4 v157, s[16:19], s46 offen lds
    s_add_u32 m0, s45, 156672
    s_nop 0
    buffer_load_dwordx4 v157, s[16:19], s47 offen lds
L_nor2_28:
    s_waitcnt lgkmcnt(3)
    v_mfma_f32_16x16x32_bf16 v[32:35], v[12:15], v[88:91], v[32:35]
    v_mfma_f32_16x16x32_bf16 v[36:39], v[88:91], v[88:91], v[36:39]
    s_waitcnt lgkmcnt(2)
    v_mfma_f32_16x16x32_bf16 v[32:35], v[12:15], v[92:95], v[32:35]
    v_mfma_f32_16x16x32_bf16 v[36:39], v[92:95], v[92:95], v[36:39]
    s_waitcnt vmcnt(12)
    s_barrier
    s_waitcnt vmcnt(10)
    ds_read_b128 v[104:107], v7 offset:16384
    ds_read_b128 v[108:111], v8 offset:16384
    s_waitcnt lgkmcnt(3)
    v_mfma_f32_16x16x32_bf16 v[32:35], v[12:15], v[96:99], v[32:35]
    v_mfma_f32_16x16x32_bf16 v[36:39], v[96:99], v[96:99], v[36:39]
    s_waitcnt lgkmcnt(2)
    v_mfma_f32_16x16x32_bf16 v[32:35], v[12:15], v[100:103], v[32:35]
    v_mfma_f32_16x16x32_bf16 v[36:39], v[100:103], v[100:103], v[36:39]
    s_waitcnt lgkmcnt(1)
    v_mfma_f32_16x16x32_bf16 v[32:35], v[12:15], v[104:107], v[32:35]
    v_mfma_f32_16x16x32_bf16 v[36:39], v[104:107], v[104:107], v[36:39]
    s_waitcnt lgkmcnt(0)
    v_mfma_f32_16x16x32_bf16 v[32:35], v[12:15], v[108:111], v[32:35]
    v_mfma_f32_16x16x32_bf16 v[36:39], v[108:111], v[108:111], v[36:39]
    s_mov_b32 exec_lo, 0x200002
    s_mov_b32 exec_hi, 0x20000200
    s_nop 5
    v_mov_b32 v36, v37
    s_mov_b32 exec_lo, 0x400004
    s_mov_b32 exec_hi, 0x40000400
    v_mov_b32 v36, v38
    s_mov_b32 exec_lo, 0x800008
    s_mov_b32 exec_hi, 0x80000800
    v_mov_b32 v36, v39
    s_mov_b32 exec_lo, 0x00f0000f
    s_mov_b32 exec_hi, 0xf0000f00
    v_mov_b32 v46, 0x3b000000
    v_mul_f32 v32, 0xbb000000, v32
    v_mul_f32 v40, v32, v32
    v_fma_f32 v40, v36, v46, -v40
    v_max_f32 v40, 0, v40
    v_add_f32 v40, 0x3727c5ac, v40
    v_rsq_f32 v40, v40
    v_and_b32 v42, 0xffff0000, v32
    v_sub_f32 v44, v32, v42
    v_cvt_pk_bf16_f32 v42, v42, v44
    ds_write_b32 v3, v42
    ds_write_b32 v3, v40 offset:256
    s_mov_b64 exec, -1
    s_waitcnt lgkmcnt(0)
    s_waitcnt vmcnt(4)
    s_barrier
    s_barrier
    s_lshl_b32 s59, s61, 3
    s_add_u32 s59, s59, s3
    s_lshr_b32 s60, s38, 3
    s_lshl_b32 s60, s60, 1
    s_lshl_b32 s50, s37, 3
    s_add_u32 s60, s60, s50
    s_and_b32 s50, s3, 1
    s_add_u32 s60, s60, s50
    v_mov_b32 v80, 0xdddddddd
    v_mov_b32 v81, v2
    v_add_u32 v83, 0x10000, v2
    v_and_b32 v82, 15, v1
    v_lshlrev_b32 v82, 4, v82
    v_lshrrev_b32 v84, 5, v1
    v_lshl_add_u32 v82, v84, 8, v82
    v_add_u32 v82, 1024, v82
    v_and_b32 v252, 31, v1
    v_lshlrev_b32 v90, 2, v252
    v_lshlrev_b32 v252, 10, v252
    v_lshl_add_u32 v252, v84, 4, v252
    v_add_u32 v84, 0x10000, v82
    s_lshl_b32 s62, s60, 15
    s_lshl_b32 s50, s61, 7
    s_add_u32 s62, s62, s50
    s_lshr_b32 s50, s3, 1
    s_lshl_b32 s50, s50, 5
    s_add_u32 s62, s62, s50
    s_bfe_u32 s50, s3, 0x10001
    s_lshl_b32 s50, s50, 8
    s_lshr_b32 s51, s3, 2
    s_lshl_b32 s51, s51, 10
    s_or_b32 s50, s50, s51
    v_xor_b32 v85, s50, v2
    v_xor_b32 v86, 1024, v85
    s_lshl_b32 s50, s3, 10
    s_add_u32 s50, s50, 131072
    v_add_u32 v253, s50, v2
    s_lshr_b32 s51, s3, 1
    s_lshl_b32 s51, s51, 14
    s_lshl_b32 s50, s61, 16
    s_add_u32 s51, s51, s50
    s_add_u32 s51, s51, 18874368
    s_mul_i32 s52, s3, 22528
    s_mul_i32 s50, s61, 180224
    s_add_u32 s52, s52, s50
    s_add_u32 s52, s52, 19922944
    s_mul_i32 s54, s3, 6144
    s_mul_i32 s53, s38, 98304
    s_add_u32 s53, s53, s54
    s_add_u32 s53, s53, 22020096
    s_cmp_ge_u32 s38, 29
    s_cselect_b32 s53, 1073741824, s53
    s_mov_b32 s48, 0x0000ffff
    s_mov_b32 s49, 0x0000ffff
    s_lshl_b32 s50, s37, 7
    s_add_u32 s50, s50, 20480
    v_add_u32 v91, s50, v90
    v_and_b32 v87, 7, v1
    v_lshlrev_b32 v87, 7, v87
    v_bfe_u32 v88, v1, 3, 2
    v_lshl_add_u32 v87, v88, 5, v87
    s_lshl_b32 s50, s37, 2
    s_add_u32 s50, s50, 20480
    s_mov_b32 exec_lo, 0
    v_add_u32 v91, s50, v87
    s_mov_b64 exec, -1
    s_lshl_b32 s55, s58, 17
    s_add_u32 s55, s55, 4194304
    s_lshl_b32 s47, s3, 11
    s_add_u32 s47, s47, 16384
    s_lshl_b32 s46, s3, 13
    s_add_u32 s46, s46, 65536
    v_mov_b32 v64, 0
    v_mov_b32 v65, 0
    v_mov_b32 v66, 0
    v_mov_b32 v67, 0
    v_mov_b32 v68, 0
    v_mov_b32 v69, 0
    v_mov_b32 v70, 0
    v_mov_b32 v71, 0
    v_mov_b32 v72, 0
    v_mov_b32 v73, 0
    v_mov_b32 v74, 0
    v_mov_b32 v75, 0
    v_mov_b32 v76, 0
    v_mov_b32 v77, 0
    v_mov_b32 v78, 0
    v_mov_b32 v79, 0
    v_mov_b32 v40, 0
    v_mov_b32 v41, 0
    v_mov_b32 v42, 0
    v_mov_b32 v43, 0
    v_mov_b32 v44, 0
    v_mov_b32 v45, 0
    v_mov_b32 v46, 0
    v_mov_b32 v47, 0
    v_mov_b32 v48, 0
    v_mov_b32 v49, 0
    v_mov_b32 v50, 0
    v_mov_b32 v51, 0
    v_mov_b32 v52, 0
    v_mov_b32 v53, 0
    v_mov_b32 v54, 0
    v_mov_b32 v55, 0
    v_mov_b32 v240, -1
    v_mov_b32 v241, -1
    v_mov_b32 v242, -1
    v_mov_b32 v243, -1
    s_mov_b32 exec_lo, 0x00110000
    s_mov_b32 exec_hi, 0x00110000
    v_mov_b32 v64, 0x3f803f80
    v_mov_b32 v65, 0x3f803f80
    v_mov_b32 v66, 0x3f803f80
    v_mov_b32 v67, 0x3f803f80
    v_mov_b32 v68, 0x3f803f80
    v_mov_b32 v69, 0x3f803f80
    v_mov_b32 v70, 0x3f803f80
    v_mov_b32 v71, 0x3f803f80
    v_mov_b32 v72, 0x3f803f80
    v_mov_b32 v73, 0x3f803f80
    v_mov_b32 v74, 0x3f803f80
    v_mov_b32 v75, 0x3f803f80
    v_mov_b32 v76, 0x3f803f80
    v_mov_b32 v77, 0x3f803f80
    v_mov_b32 v78, 0x3f803f80
    v_mov_b32 v79, 0x3f803f80
    s_mov_b64 exec, -1
    s_and_b32 s42, s100, 1
    s_lshl_b32 s42, s42, 11
    s_add_u32 s42, s42, 155648
    v_lshrrev_b32 v162, 5, v1
    v_lshlrev_b32 v162, 10, v162
    v_bfe_u32 v163, v1, 2, 2
    v_lshl_add_u32 v162, v163, 7, v162
    v_bfe_u32 v163, v1, 4, 1
    v_mul_u32_u24 v163, 32, v163
    v_add_u32 v162, v162, v163
    v_and_b32 v163, 1, v1
    v_lshl_add_u32 v162, v163, 4, v162
    v_bfe_u32 v163, v1, 1, 1
    v_lshl_add_u32 v162, v163, 3, v162
    v_add_u32 v162, s42, v162
    v_add_u32 v163, 512, v162
    v_add_u32 v164, 64, v162
    v_add_u32 v165, 576, v162
    s_cmp_eq_u32 s100, 0
    s_cselect_b32 s42, 0, 80
    s_mov_b32 s43, 180224
    s_mov_b32 s31, 19922944
    s_cselect_b32 s43, 65536, s43
    s_cselect_b32 s31, 18874368, s31
    s_add_u32 s42, s42, s38
    s_mul_i32 s43, s43, s37
    s_add_u32 s31, s31, s43
    s_lshl_b32 s43, s42, 11
    s_add_u32 s31, s31, s43
    s_lshl_b32 s43, s100, 8
    s_add_u32 s43, s43, s2
    s_cmp_ge_u32 s43, 320
    s_cselect_b32 s31, 1073741824, s31
    v_mov_b32 v166, 161544
    v_mov_b32 v167, 1
    s_lshl_b32 s45, s100, 12
    s_add_u32 s45, s45, 139264
    s_cmp_ge_u32 s2, 176
    s_cbranch_scc1 L_pa2_29
    v_lshrrev_b32 v158, 5, v1
    v_lshlrev_b32 v158, 9, v158
    v_bfe_u32 v159, v1, 2, 2
    v_lshl_add_u32 v158, v159, 6, v158
    v_bfe_u32 v159, v1, 4, 1
    v_mul_u32_u24 v159, 1024, v159
    v_add_u32 v158, v158, v159
    v_and_b32 v159, 1, v1
    v_lshl_add_u32 v158, v159, 4, v158
    v_bfe_u32 v159, v1, 1, 1
    v_lshl_add_u32 v158, v159, 3, v158
    v_add_u32 v158, s45, v158
    v_add_u32 v159, 256, v158
    v_add_u32 v160, 2048, v158
    v_add_u32 v161, 2304, v158
    s_mov_b32 s30, 32
    s_lshr_b32 s43, s2, 4
    s_lshl_b32 s43, s43, 2
    s_add_u32 s43, s43, s100
    s_lshl_b32 s43, s43, 1
    s_and_b32 s42, s2, 15
    s_mul_i32 s42, s42, 6144
    s_add_u32 s42, s42, 22020096
    s_mul_i32 s8, s43, 43691
    s_lshr_b32 s8, s8, 17
    s_mul_i32 s8, s8, 95232
    s_lshl_b32 s9, s43, 10
    s_add_u32 s8, s8, s9
    s_add_u32 s8, s8, s42
    s_add_u32 s9, s8, 3072
    s_add_u32 s43, s43, 1
    s_mul_i32 s10, s43, 43691
    s_lshr_b32 s10, s10, 17
    s_mul_i32 s10, s10, 95232
    s_lshl_b32 s11, s43, 10
    s_add_u32 s10, s10, s11
    s_add_u32 s10, s10, s42
    s_add_u32 s11, s10, 3072
    s_branch L_pad_30
L_pa2_29:
    v_lshrrev_b32 v158, 5, v1
    v_lshlrev_b32 v158, 10, v158
    v_bfe_u32 v159, v1, 2, 2
    v_lshl_add_u32 v158, v159, 7, v158
    v_bfe_u32 v159, v1, 4, 1
    v_mul_u32_u24 v159, 32, v159
    v_add_u32 v158, v158, v159
    v_and_b32 v159, 1, v1
    v_lshl_add_u32 v158, v159, 4, v158
    v_bfe_u32 v159, v1, 1, 1
    v_lshl_add_u32 v158, v159, 3, v158
    v_add_u32 v158, s45, v158
    v_add_u32 v159, 512, v158
    v_add_u32 v160, 64, v158
    v_add_u32 v161, 576, v158
    s_mov_b32 s30, 2048
    s_sub_u32 s43, s2, 176
    s_lshl_b32 s8, s43, 11
    s_mul_i32 s9, s100, 360448
    s_add_u32 s8, s8, s9
    s_add_u32 s8, s8, 19922944
    s_add_u32 s9, s8, 1024
    s_add_u32 s10, s8, 180224
    s_add_u32 s11, s9, 180224
L_pad_30:
    s_waitcnt vmcnt(0)
    ds_read_b64_tr_b16 v[168:169], v158
    ds_read_b64_tr_b16 v[170:171], v159
    ds_read_b64_tr_b16 v[172:173], v160
    ds_read_b64_tr_b16 v[174:175], v161
    v_add_u32 v158, s30, v158
    ds_read_b64_tr_b16 v[176:177], v158
    v_add_u32 v159, s30, v159
    ds_read_b64_tr_b16 v[178:179], v159
    v_add_u32 v160, s30, v160
    ds_read_b64_tr_b16 v[180:181], v160
    v_add_u32 v161, s30, v161
    ds_read_b64_tr_b16 v[182:183], v161
    ds_read_b64_tr_b16 v[184:185], v162
    ds_read_b64_tr_b16 v[186:187], v163
    ds_read_b64_tr_b16 v[188:189], v164
    ds_read_b64_tr_b16 v[190:191], v165
    s_waitcnt lgkmcnt(10)
    buffer_store_dwordx4 v[168:171], v2, s[12:15], s8 offen sc1
    s_waitcnt lgkmcnt(8)
    buffer_store_dwordx4 v[172:175], v2, s[12:15], s9 offen sc1
    s_waitcnt lgkmcnt(6)
    buffer_store_dwordx4 v[176:179], v2, s[12:15], s10 offen sc1
    s_waitcnt lgkmcnt(4)
    buffer_store_dwordx4 v[180:183], v2, s[12:15], s11 offen sc1
    s_waitcnt lgkmcnt(2)
    buffer_store_dwordx4 v[184:187], v2, s[12:15], s31 offen offset:0 sc1
    s_waitcnt lgkmcnt(0)
    buffer_store_dwordx4 v[188:191], v2, s[12:15], s31 offen offset:1024 sc1
    s_barrier
    ds_read_b128 v[4:7], v253
    ds_read_b128 v[56:59], v81 offset:0
    ds_read_b128 v[60:63], v81 offset:2048
    s_mov_b64 exec, s[48:49]
    ds_read_b128 v[64:67], v82 offset:0
    ds_read_b128 v[68:71], v82 offset:512
    s_mov_b64 exec, -1
    s_waitcnt lgkmcnt(3)
    v_mfma_f32_32x32x16_bf16 v[8:23], v[56:59], v[4:7], 0
    s_setprio 1
    s_nop 10
    v_exp_f32 v8, v8
    v_exp_f32 v9, v9
    s_add_u32 m0, s47, 0
    s_add_u32 s45, s55, m0
    buffer_load_dwordx4 v2, s[12:15], s45 offen offset:0 sc1 lds
    s_sub_u32 m0, s45, s55
    s_nop 0
    buffer_load_dwordx4 v2, s[12:15], s45 offen offset:1024 sc1 lds
    v_exp_f32 v10, v10
    v_exp_f32 v11, v11
    v_exp_f32 v12, v12
    v_exp_f32 v13, v13
    v_exp_f32 v14, v14
    s_waitcnt lgkmcnt(2)
    v_mfma_f32_32x32x16_bf16 v[24:39], v[60:63], v[4:7], 0
    ds_read_b128 v[56:59], v81 offset:4096
    v_exp_f32 v15, v15
    v_exp_f32 v16, v16
    v_exp_f32 v17, v17
    v_exp_f32 v18, v18
    v_exp_f32 v19, v19
    s_waitcnt lgkmcnt(2)
    v_smfmac_f32_32x32x32_bf16 v[40:55], v[64:67], v[8:15], v80
    s_mov_b64 exec, s[48:49]
    ds_read_b128 v[72:75], v82 offset:2048
    ds_read_b128 v[76:79], v82 offset:2560
    s_mov_b64 exec, -1
    v_exp_f32 v20, v20
    v_exp_f32 v21, v21
    v_exp_f32 v22, v22
    v_exp_f32 v23, v23
    v_exp_f32 v24, v24
    v_exp_f32 v25, v25
    s_waitcnt lgkmcnt(3)
    v_smfmac_f32_32x32x32_bf16 v[40:55], v[68:71], v[16:23], v80
    s_add_u32 m0, s47, 16384
    s_add_u32 s45, s55, m0
    buffer_load_dwordx4 v2, s[12:15], s45 offen offset:0 sc1 lds
    s_sub_u32 m0, s45, s55
    s_nop 0
    buffer_load_dwordx4 v2, s[12:15], s45 offen offset:1024 sc1 lds
    v_exp_f32 v26, v26
    v_exp_f32 v27, v27
    v_exp_f32 v28, v28
    v_exp_f32 v29, v29
    v_exp_f32 v30, v30
    s_waitcnt lgkmcnt(2)
    v_mfma_f32_32x32x16_bf16 v[8:23], v[56:59], v[4:7], 0
    ds_read_b128 v[60:63], v81 offset:6144
    v_exp_f32 v31, v31
    v_exp_f32 v32, v32
    v_exp_f32 v33, v33
    v_exp_f32 v34, v34
    v_exp_f32 v35, v35
    s_waitcnt lgkmcnt(2)
    v_smfmac_f32_32x32x32_bf16 v[40:55], v[72:75], v[24:31], v80
    s_mov_b64 exec, s[48:49]
    ds_read_b128 v[64:67], v82 offset:4096
    ds_read_b128 v[68:71], v82 offset:4608
    s_mov_b64 exec, -1
    v_exp_f32 v36, v36
    v_exp_f32 v37, v37
    v_exp_f32 v38, v38
    v_exp_f32 v39, v39
    v_exp_f32 v8, v8
    v_exp_f32 v9, v9
    s_waitcnt lgkmcnt(3)
    v_smfmac_f32_32x32x32_bf16 v[40:55], v[76:79], v[32:39], v80
    s_add_u32 m0, s47, 32768
    s_add_u32 s45, s55, m0
    buffer_load_dwordx4 v2, s[12:15], s45 offen offset:0 sc1 lds
    s_sub_u32 m0, s45, s55
    s_nop 0
    buffer_load_dwordx4 v2, s[12:15], s45 offen offset:1024 sc1 lds
    s_waitcnt vmcnt(6)
    s_mov_b64 exec, 1
    ds_add_rtn_u32 v167, v166, v167
    s_mov_b64 exec, -1
    v_exp_f32 v10, v10
    v_exp_f32 v11, v11
    v_exp_f32 v12, v12
    v_exp_f32 v13, v13
    v_exp_f32 v14, v14
    s_waitcnt lgkmcnt(3)
    v_mfma_f32_32x32x16_bf16 v[24:39], v[60:63], v[4:7], 0
    ds_read_b128 v[56:59], v81 offset:8192
    v_exp_f32 v15, v15
    v_exp_f32 v16, v16
    v_exp_f32 v17, v17
    v_exp_f32 v18, v18
    v_exp_f32 v19, v19
    s_waitcnt lgkmcnt(3)
    v_smfmac_f32_32x32x32_bf16 v[40:55], v[64:67], v[8:15], v80
    s_mov_b64 exec, s[48:49]
    ds_read_b128 v[72:75], v82 offset:6144
    ds_read_b128 v[76:79], v82 offset:6656
    s_mov_b64 exec, -1
    v_exp_f32 v20, v20
    v_exp_f32 v21, v21
    v_exp_f32 v22, v22
    v_exp_f32 v23, v23
    v_exp_f32 v24, v24
    v_exp_f32 v25, v25
    s_waitcnt lgkmcnt(4)
    v_smfmac_f32_32x32x32_bf16 v[40:55], v[68:71], v[16:23], v80
    s_add_u32 m0, s46, 0
    s_add_u32 s45, s55, m0
    buffer_load_dwordx4 v2, s[12:15], s45 offen offset:0 sc1 lds
    s_waitcnt lgkmcnt(3)
    v_readfirstlane_b32 s42, v167
    v_mov_b32 v166, s36
    s_lshl_b32 s43, s37, 5
    s_add_u32 s43, s43, s38
    s_lshl_b32 s43, s43, 2
    s_add_u32 s43, s43, 16384
    s_cmp_eq_u32 s42, 3
    s_cselect_b32 s43, s43, 1073741824
    s_mov_b64 exec, 1
    buffer_store_dword v166, off, s[12:15], s43 sc1
    s_mov_b64 exec, -1
    v_exp_f32 v26, v26
    v_exp_f32 v27, v27
    v_exp_f32 v28, v28
    v_exp_f32 v29, v29
    v_exp_f32 v30, v30
    s_waitcnt lgkmcnt(2)
    v_mfma_f32_32x32x16_bf16 v[8:23], v[56:59], v[4:7], 0
    ds_read_b128 v[60:63], v81 offset:10240
    v_exp_f32 v31, v31
    v_exp_f32 v32, v32
    v_exp_f32 v33, v33
    v_exp_f32 v34, v34
    v_exp_f32 v35, v35
    s_waitcnt lgkmcnt(2)
    v_smfmac_f32_32x32x32_bf16 v[40:55], v[72:75], v[24:31], v80
    s_mov_b64 exec, s[48:49]
    ds_read_b128 v[64:67], v82 offset:8192
    ds_read_b128 v[68:71], v82 offset:8704
    s_mov_b64 exec, -1
    v_exp_f32 v36, v36
    v_exp_f32 v37, v37
    v_exp_f32 v38, v38
    v_exp_f32 v39, v39
    v_exp_f32 v8, v8
    v_exp_f32 v9, v9
    s_waitcnt lgkmcnt(3)
    v_smfmac_f32_32x32x32_bf16 v[40:55], v[76:79], v[32:39], v80
    s_sub_u32 m0, s45, s55
    s_nop 0
    buffer_load_dwordx4 v2, s[12:15], s45 offen offset:1024 sc1 lds
    v_exp_f32 v10, v10
    v_exp_f32 v11, v11
    v_exp_f32 v12, v12
    v_exp_f32 v13, v13
    v_exp_f32 v14, v14
    s_waitcnt lgkmcnt(2)
    v_mfma_f32_32x32x16_bf16 v[24:39], v[60:63], v[4:7], 0
    ds_read_b128 v[56:59], v81 offset:12288
    v_exp_f32 v15, v15
    v_exp_f32 v16, v16
    v_exp_f32 v17, v17
    v_exp_f32 v18, v18
    v_exp_f32 v19, v19
    s_waitcnt lgkmcnt(2)
    v_smfmac_f32_32x32x32_bf16 v[40:55], v[64:67], v[8:15], v80
    s_mov_b64 exec, s[48:49]
    ds_read_b128 v[72:75], v82 offset:10240
    ds_read_b128 v[76:79], v82 offset:10752
    s_mov_b64 exec, -1
    v_exp_f32 v20, v20
    v_exp_f32 v21, v21
    v_exp_f32 v22, v22
    v_exp_f32 v23, v23
    v_exp_f32 v24, v24
    v_exp_f32 v25, v25
    s_waitcnt lgkmcnt(3)
    v_smfmac_f32_32x32x32_bf16 v[40:55], v[68:71], v[16:23], v80
    s_sub_u32 m0, s45, s55
    s_nop 0
    buffer_load_dwordx4 v2, s[12:15], s45 offen offset:2048 sc1 lds
    v_exp_f32 v26, v26
    v_exp_f32 v27, v27
    v_exp_f32 v28, v28
    v_exp_f32 v29, v29
    v_exp_f32 v30, v30
    s_waitcnt lgkmcnt(2)
    v_mfma_f32_32x32x16_bf16 v[8:23], v[56:59], v[4:7], 0
    ds_read_b128 v[60:63], v81 offset:14336
    v_exp_f32 v31, v31
    v_exp_f32 v32, v32
    v_exp_f32 v33, v33
    v_exp_f32 v34, v34
    v_exp_f32 v35, v35
    s_waitcnt lgkmcnt(2)
    v_smfmac_f32_32x32x32_bf16 v[40:55], v[72:75], v[24:31], v80
    s_mov_b64 exec, s[48:49]
    ds_read_b128 v[64:67], v82 offset:12288
    ds_read_b128 v[68:71], v82 offset:12800
    s_mov_b64 exec, -1
    v_exp_f32 v36, v36
    v_exp_f32 v37, v37
    v_exp_f32 v38, v38
    v_exp_f32 v39, v39
    s_waitcnt vmcnt(8)
    s_barrier
    v_exp_f32 v8, v8
    v_exp_f32 v9, v9
    s_waitcnt lgkmcnt(3)
    v_smfmac_f32_32x32x32_bf16 v[40:55], v[76:79], v[32:39], v80
    s_sub_u32 m0, s45, s55
    s_nop 0
    buffer_load_dwordx4 v2, s[12:15], s45 offen offset:3072 sc1 lds
    v_exp_f32 v10, v10
    v_exp_f32 v11, v11
    v_exp_f32 v12, v12
    v_exp_f32 v13, v13
    v_exp_f32 v14, v14
    s_waitcnt lgkmcnt(2)
    v_mfma_f32_32x32x16_bf16 v[24:39], v[60:63], v[4:7], 0
    ds_read_b128 v[56:59], v81 offset:16384
    v_exp_f32 v15, v15
    v_exp_f32 v16, v16
    v_exp_f32 v17, v17
    v_exp_f32 v18, v18
    v_exp_f32 v19, v19
    s_waitcnt lgkmcnt(2)
    v_smfmac_f32_32x32x32_bf16 v[40:55], v[64:67], v[8:15], v80
    s_mov_b64 exec, s[48:49]
    ds_read_b128 v[72:75], v82 offset:14336
    ds_read_b128 v[76:79], v82 offset:14848
    s_mov_b64 exec, -1
    v_exp_f32 v20, v20
    v_exp_f32 v21, v21
    v_exp_f32 v22, v22
    v_exp_f32 v23, v23
    v_exp_f32 v24, v24
    v_exp_f32 v25, v25
    s_waitcnt lgkmcnt(3)
    v_smfmac_f32_32x32x32_bf16 v[40:55], v[68:71], v[16:23], v80
    s_add_u32 m0, s46, 4096
    s_add_u32 s45, s55, m0
    buffer_load_dwordx4 v2, s[12:15], s45 offen offset:0 sc1 lds
    v_exp_f32 v26, v26
    v_exp_f32 v27, v27
    v_exp_f32 v28, v28
    v_exp_f32 v29, v29
    v_exp_f32 v30, v30
    s_waitcnt lgkmcnt(2)
    v_mfma_f32_32x32x16_bf16 v[8:23], v[56:59], v[4:7], 0
    ds_read_b128 v[60:63], v81 offset:18432
    v_exp_f32 v31, v31
    v_exp_f32 v32, v32
    v_exp_f32 v33, v33
    v_exp_f32 v34, v34
    v_exp_f32 v35, v35
    s_waitcnt lgkmcnt(2)
    v_smfmac_f32_32x32x32_bf16 v[40:55], v[72:75], v[24:31], v80
    s_mov_b64 exec, s[48:49]
    ds_read_b128 v[64:67], v82 offset:16384
    ds_read_b128 v[68:71], v82 offset:16896
    s_mov_b64 exec, -1
    v_exp_f32 v36, v36
    v_exp_f32 v37, v37
    v_exp_f32 v38, v38
    v_exp_f32 v39, v39
    v_exp_f32 v8, v8
    v_exp_f32 v9, v9
    s_waitcnt lgkmcnt(3)
    v_smfmac_f32_32x32x32_bf16 v[40:55], v[76:79], v[32:39], v80
    s_sub_u32 m0, s45, s55
    s_nop 0
    buffer_load_dwordx4 v2, s[12:15], s45 offen offset:1024 sc1 lds
    v_exp_f32 v10, v10
    v_exp_f32 v11, v11
    v_exp_f32 v12, v12
    v_exp_f32 v13, v13
    v_exp_f32 v14, v14
    s_waitcnt lgkmcnt(2)
    v_mfma_f32_32x32x16_bf16 v[24:39], v[60:63], v[4:7], 0
    ds_read_b128 v[56:59], v81 offset:20480
    v_exp_f32 v15, v15
    v_exp_f32 v16, v16
    v_exp_f32 v17, v17
    v_exp_f32 v18, v18
    v_exp_f32 v19, v19
    s_waitcnt lgkmcnt(2)
    v_smfmac_f32_32x32x32_bf16 v[40:55], v[64:67], v[8:15], v80
    s_mov_b64 exec, s[48:49]
    ds_read_b128 v[72:75], v82 offset:18432
    ds_read_b128 v[76:79], v82 offset:18944
    s_mov_b64 exec, -1
    v_exp_f32 v20, v20
    v_exp_f32 v21, v21
    v_exp_f32 v22, v22
    v_exp_f32 v23, v23
    v_exp_f32 v24, v24
    v_exp_f32 v25, v25
    s_waitcnt lgkmcnt(3)
    v_smfmac_f32_32x32x32_bf16 v[40:55], v[68:71], v[16:23], v80
    s_sub_u32 m0, s45, s55
    s_nop 0
    buffer_load_dwordx4 v2, s[12:15], s45 offen offset:2048 sc1 lds
    v_exp_f32 v26, v26
    v_exp_f32 v27, v27
    v_exp_f32 v28, v28
    v_exp_f32 v29, v29
    v_exp_f32 v30, v30
    s_waitcnt lgkmcnt(2)
    v_mfma_f32_32x32x16_bf16 v[8:23], v[56:59], v[4:7], 0
    ds_read_b128 v[60:63], v81 offset:22528
    v_exp_f32 v31, v31
    v_exp_f32 v32, v32
    v_exp_f32 v33, v33
    v_exp_f32 v34, v34
    v_exp_f32 v35, v35
    s_waitcnt lgkmcnt(2)
    v_smfmac_f32_32x32x32_bf16 v[40:55], v[72:75], v[24:31], v80
    s_mov_b64 exec, s[48:49]
    ds_read_b128 v[64:67], v82 offset:20480
    ds_read_b128 v[68:71], v82 offset:20992
    s_mov_b64 exec, -1
    v_exp_f32 v36, v36
    v_exp_f32 v37, v37
    v_exp_f32 v38, v38
    v_exp_f32 v39, v39
    v_exp_f32 v8, v8
    v_exp_f32 v9, v9
    s_waitcnt lgkmcnt(3)
    v_smfmac_f32_32x32x32_bf16 v[40:55], v[76:79], v[32:39], v80
    s_sub_u32 m0, s45, s55
    s_nop 0
    buffer_load_dwordx4 v2, s[12:15], s45 offen offset:3072 sc1 lds
    v_exp_f32 v10, v10
    v_exp_f32 v11, v11
    v_exp_f32 v12, v12
    v_exp_f32 v13, v13
    v_exp_f32 v14, v14
    s_waitcnt lgkmcnt(2)
    v_mfma_f32_32x32x16_bf16 v[24:39], v[60:63], v[4:7], 0
    ds_read_b128 v[56:59], v81 offset:24576
    v_exp_f32 v15, v15
    v_exp_f32 v16, v16
    v_exp_f32 v17, v17
    v_exp_f32 v18, v18
    v_exp_f32 v19, v19
    s_waitcnt lgkmcnt(2)
    v_smfmac_f32_32x32x32_bf16 v[40:55], v[64:67], v[8:15], v80
    s_mov_b64 exec, s[48:49]
    ds_read_b128 v[72:75], v82 offset:22528
    ds_read_b128 v[76:79], v82 offset:23040
    s_mov_b64 exec, -1
    v_exp_f32 v20, v20
    v_exp_f32 v21, v21
    v_exp_f32 v22, v22
    v_exp_f32 v23, v23
    v_exp_f32 v24, v24
    v_exp_f32 v25, v25
    s_waitcnt lgkmcnt(3)
    v_smfmac_f32_32x32x32_bf16 v[40:55], v[68:71], v[16:23], v80
    s_lshl_b32 s44, s37, 7
    s_add_u32 s44, s44, 4096
    buffer_load_dword v89, v90, s[12:15], s44 offen sc1
    s_cmp_eq_u32 s3, 7
    s_cselect_b32 s101, 16384, 1073741824
    buffer_load_dwordx4 v[192:195], v2, s[12:15], s101 offen sc1
    v_exp_f32 v26, v26
    v_exp_f32 v27, v27
    v_exp_f32 v28, v28
    v_exp_f32 v29, v29
    v_exp_f32 v30, v30
    s_waitcnt lgkmcnt(2)
    v_mfma_f32_32x32x16_bf16 v[8:23], v[56:59], v[4:7], 0
    ds_read_b128 v[60:63], v81 offset:26624
    v_exp_f32 v31, v31
    v_exp_f32 v32, v32
    v_exp_f32 v33, v33
    v_exp_f32 v34, v34
    v_exp_f32 v35, v35
    s_waitcnt lgkmcnt(2)
    v_smfmac_f32_32x32x32_bf16 v[40:55], v[72:75], v[24:31], v80
    s_mov_b64 exec, s[48:49]
    ds_read_b128 v[64:67], v82 offset:24576
    ds_read_b128 v[68:71], v82 offset:25088
    s_mov_b64 exec, -1
    v_exp_f32 v36, v36
    v_exp_f32 v37, v37
    v_exp_f32 v38, v38
    v_exp_f32 v39, v39
    v_exp_f32 v8, v8
    v_exp_f32 v9, v9
    s_waitcnt lgkmcnt(3)
    v_smfmac_f32_32x32x32_bf16 v[40:55], v[76:79], v[32:39], v80
    v_exp_f32 v10, v10
    v_exp_f32 v11, v11
    v_exp_f32 v12, v12
    v_exp_f32 v13, v13
    v_exp_f32 v14, v14
    s_waitcnt lgkmcnt(2)
    v_mfma_f32_32x32x16_bf16 v[24:39], v[60:63], v[4:7], 0
    ds_read_b128 v[56:59], v81 offset:28672
    v_exp_f32 v15, v15
    v_exp_f32 v16, v16
    v_exp_f32 v17, v17
    v_exp_f32 v18, v18
    v_exp_f32 v19, v19
    s_waitcnt lgkmcnt(2)
    v_smfmac_f32_32x32x32_bf16 v[40:55], v[64:67], v[8:15], v80
    s_mov_b64 exec, s[48:49]
    ds_read_b128 v[72:75], v82 offset:26624
    ds_read_b128 v[76:79], v82 offset:27136
    s_mov_b64 exec, -1
    v_exp_f32 v20, v20
    v_exp_f32 v21, v21
    v_exp_f32 v22, v22
    v_exp_f32 v23, v23
    v_exp_f32 v24, v24
    v_exp_f32 v25, v25
    s_waitcnt lgkmcnt(3)
    v_smfmac_f32_32x32x32_bf16 v[40:55], v[68:71], v[16:23], v80
    v_exp_f32 v26, v26
    v_exp_f32 v27, v27
    v_exp_f32 v28, v28
    v_exp_f32 v29, v29
    v_exp_f32 v30, v30
    s_waitcnt lgkmcnt(2)
    v_mfma_f32_32x32x16_bf16 v[8:23], v[56:59], v[4:7], 0
    ds_read_b128 v[60:63], v81 offset:30720
    v_exp_f32 v31, v31
    v_exp_f32 v32, v32
    v_exp_f32 v33, v33
    v_exp_f32 v34, v34
    v_exp_f32 v35, v35
    s_waitcnt lgkmcnt(2)
    v_smfmac_f32_32x32x32_bf16 v[40:55], v[72:75], v[24:31], v80
    s_mov_b64 exec, s[48:49]
    ds_read_b128 v[64:67], v82 offset:28672
    ds_read_b128 v[68:71], v82 offset:29184
    s_mov_b64 exec, -1
    v_exp_f32 v36, v36
    v_exp_f32 v37, v37
    v_exp_f32 v38, v38
    v_exp_f32 v39, v39
    s_waitcnt vmcnt(11)
    s_waitcnt vmcnt(0)
    s_cmp_lg_u32 s3, 7
    s_cbranch_scc1 L_nofl_31
    s_mov_b32 s41, 131072
    s_branch L_pchk_34
L_poll_32:
    buffer_load_dwordx4 v[192:195], v2, s[12:15], s101 offen sc1
    s_waitcnt vmcnt(0)
L_pchk_34:
    v_cmp_ne_u32 vcc, s36, v192
    v_cmp_ne_u32 s[42:43], s36, v193
    s_or_b64 vcc, vcc, s[42:43]
    v_cmp_ne_u32 s[42:43], s36, v194
    s_or_b64 vcc, vcc, s[42:43]
    v_cmp_ne_u32 s[42:43], s36, v195
    s_or_b64 vcc, vcc, s[42:43]
    s_cbranch_vccz L_pdone_33
    s_sub_u32 s41, s41, 1
    s_cbranch_scc0 L_poll_32
L_pdone_33:
L_nofl_31:
    s_barrier
    v_exp_f32 v8, v8
    v_exp_f32 v9, v9
    s_waitcnt lgkmcnt(3)
    v_smfmac_f32_32x32x32_bf16 v[40:55], v[76:79], v[32:39], v80
    v_cmp_ne_u32 vcc, s40, v89
    s_cmp_eq_u64 vcc, 0
    s_cselect_b32 s39, 1, 0
    s_lshl_b32 s42, s59, 5
    s_add_u32 s42, s42, s58
    s_lshl_b32 s42, s42, 10
    s_add_u32 s42, s42, 8388608
    buffer_store_dwordx4 v[240:243], v2, s[12:15], s42 offen sc1
    v_exp_f32 v10, v10
    v_exp_f32 v11, v11
    v_exp_f32 v12, v12
    v_exp_f32 v13, v13
    v_exp_f32 v14, v14
    s_waitcnt lgkmcnt(2)
    v_mfma_f32_32x32x16_bf16 v[24:39], v[60:63], v[4:7], 0
    ds_read_b128 v[56:59], v81 offset:32768
    v_exp_f32 v15, v15
    v_exp_f32 v16, v16
    v_exp_f32 v17, v17
    v_exp_f32 v18, v18
    v_exp_f32 v19, v19
    s_waitcnt lgkmcnt(2)
    v_smfmac_f32_32x32x32_bf16 v[40:55], v[64:67], v[8:15], v80
    s_mov_b64 exec, s[48:49]
    ds_read_b128 v[72:75], v82 offset:30720
    ds_read_b128 v[76:79], v82 offset:31232
    s_mov_b64 exec, -1
    buffer_load_dwordx4 v[92:95], v85, s[12:15], s51 offen offset:0
    v_exp_f32 v20, v20
    v_exp_f32 v21, v21
    v_exp_f32 v22, v22
    v_exp_f32 v23, v23
    v_exp_f32 v24, v24
    v_exp_f32 v25, v25
    s_waitcnt lgkmcnt(3)
    v_smfmac_f32_32x32x32_bf16 v[40:55], v[68:71], v[16:23], v80
    buffer_load_dwordx4 v[96:99], v86, s[12:15], s51 offen offset:0
    v_exp_f32 v26, v26
    v_exp_f32 v27, v27
    v_exp_f32 v28, v28
    v_exp_f32 v29, v29
    v_exp_f32 v30, v30
    s_waitcnt lgkmcnt(2)
    v_mfma_f32_32x32x16_bf16 v[8:23], v[56:59], v[4:7], 0
    ds_read_b128 v[60:63], v81 offset:34816
    v_exp_f32 v31, v31
    v_exp_f32 v32, v32
    v_exp_f32 v33, v33
    v_exp_f32 v34, v34
    v_exp_f32 v35, v35
    s_waitcnt lgkmcnt(2)
    v_smfmac_f32_32x32x32_bf16 v[40:55], v[72:75], v[24:31], v80
    s_mov_b64 exec, s[48:49]
    ds_read_b128 v[64:67], v82 offset:32768
    ds_read_b128 v[68:71], v82 offset:33280
    s_mov_b64 exec, -1
    v_exp_f32 v36, v36
    v_exp_f32 v37, v37
    v_exp_f32 v38, v38
    v_exp_f32 v39, v39
    v_exp_f32 v8, v8
    v_exp_f32 v9, v9
    s_waitcnt lgkmcnt(3)
    v_smfmac_f32_32x32x32_bf16 v[40:55], v[76:79], v[32:39], v80
    buffer_load_dwordx4 v[100:103], v85, s[12:15], s51 offen offset:2048
    v_exp_f32 v10, v10
    v_exp_f32 v11, v11
    v_exp_f32 v12, v12
    v_exp_f32 v13, v13
    v_exp_f32 v14, v14
    s_waitcnt lgkmcnt(2)
    v_mfma_f32_32x32x16_bf16 v[24:39], v[60:63], v[4:7], 0
    ds_read_b128 v[56:59], v81 offset:36864
    v_exp_f32 v15, v15
    v_exp_f32 v16, v16
    v_exp_f32 v17, v17
    v_exp_f32 v18, v18
    v_exp_f32 v19, v19
    s_waitcnt lgkmcnt(2)
    v_smfmac_f32_32x32x32_bf16 v[40:55], v[64:67], v[8:15], v80
    s_mov_b64 exec, s[48:49]
    ds_read_b128 v[72:75], v82 offset:34816
    ds_read_b128 v[76:79], v82 offset:35328
    s_mov_b64 exec, -1
    v_exp_f32 v20, v20
    v_exp_f32 v21, v21
    v_exp_f32 v22, v22
    v_exp_f32 v23, v23
    v_exp_f32 v24, v24
    v_exp_f32 v25, v25
    s_waitcnt lgkmcnt(3)
    v_smfmac_f32_32x32x32_bf16 v[40:55], v[68:71], v[16:23], v80
    buffer_load_dwordx4 v[104:107], v86, s[12:15], s51 offen offset:2048
    s_add_u32 s51, s51, 4096
    v_exp_f32 v26, v26
    v_exp_f32 v27, v27
    v_exp_f32 v28, v28
    v_exp_f32 v29, v29
    v_exp_f32 v30, v30
    s_waitcnt lgkmcnt(2)
    v_mfma_f32_32x32x16_bf16 v[8:23], v[56:59], v[4:7], 0
    ds_read_b128 v[60:63], v81 offset:38912
    v_exp_f32 v31, v31
    v_exp_f32 v32, v32
    v_exp_f32 v33, v33
    v_exp_f32 v34, v34
    v_exp_f32 v35, v35
    s_waitcnt lgkmcnt(2)
    v_smfmac_f32_32x32x32_bf16 v[40:55], v[72:75], v[24:31], v80
    s_mov_b64 exec, s[48:49]
    ds_read_b128 v[64:67], v82 offset:36864
    ds_read_b128 v[68:71], v82 offset:37376
    s_mov_b64 exec, -1
    v_exp_f32 v36, v36
    v_exp_f32 v37, v37
    v_exp_f32 v38, v38
    v_exp_f32 v39, v39
    v_exp_f32 v8, v8
    v_exp_f32 v9, v9
    s_waitcnt lgkmcnt(3)
    v_smfmac_f32_32x32x32_bf16 v[40:55], v[76:79], v[32:39], v80
    buffer_load_dwordx4 v[108:111], v85, s[12:15], s51 offen offset:0
    v_exp_f32 v10, v10
    v_exp_f32 v11, v11
    v_exp_f32 v12, v12
    v_exp_f32 v13, v13
    v_exp_f32 v14, v14
    s_waitcnt lgkmcnt(2)
    v_mfma_f32_32x32x16_bf16 v[24:39], v[60:63], v[4:7], 0
    ds_read_b128 v[56:59], v81 offset:40960
    v_exp_f32 v15, v15
    v_exp_f32 v16, v16
    v_exp_f32 v17, v17
    v_exp_f32 v18, v18
    v_exp_f32 v19, v19
    s_waitcnt lgkmcnt(2)
    v_smfmac_f32_32x32x32_bf16 v[40:55], v[64:67], v[8:15], v80
    s_mov_b64 exec, s[48:49]
    ds_read_b128 v[72:75], v82 offset:38912
    ds_read_b128 v[76:79], v82 offset:39424
    s_mov_b64 exec, -1
    v_exp_f32 v20, v20
    v_exp_f32 v21, v21
    v_exp_f32 v22, v22
    v_exp_f32 v23, v23
    v_exp_f32 v24, v24
    v_exp_f32 v25, v25
    s_waitcnt lgkmcnt(3)
    v_smfmac_f32_32x32x32_bf16 v[40:55], v[68:71], v[16:23], v80
    buffer_load_dwordx4 v[112:115], v86, s[12:15], s51 offen offset:0
    v_exp_f32 v26, v26
    v_exp_f32 v27, v27
    v_exp_f32 v28, v28
    v_exp_f32 v29, v29
    v_exp_f32 v30, v30
    s_waitcnt lgkmcnt(2)
    v_mfma_f32_32x32x16_bf16 v[8:23], v[56:59], v[4:7], 0
    ds_read_b128 v[60:63], v81 offset:43008
    v_exp_f32 v31, v31
    v_exp_f32 v32, v32
    v_exp_f32 v33, v33
    v_exp_f32 v34, v34
    v_exp_f32 v35, v35
    s_waitcnt lgkmcnt(2)
    v_smfmac_f32_32x32x32_bf16 v[40:55], v[72:75], v[24:31], v80
    s_mov_b64 exec, s[48:49]
    ds_read_b128 v[64:67], v82 offset:40960
    ds_read_b128 v[68:71], v82 offset:41472
    s_mov_b64 exec, -1
    v_exp_f32 v36, v36
    v_exp_f32 v37, v37
    v_exp_f32 v38, v38
    v_exp_f32 v39, v39
    v_exp_f32 v8, v8
    v_exp_f32 v9, v9
    s_waitcnt lgkmcnt(3)
    v_smfmac_f32_32x32x32_bf16 v[40:55], v[76:79], v[32:39], v80
    s_lshl_b32 s43, s60, 3
    s_add_u32 s43, s43, s61
    s_lshl_b32 s43, s43, 2
    s_lshr_b32 s44, s3, 1
    s_add_u32 s43, s43, s44
    s_lshl_b32 s43, s43, 10
    s_add_u32 s43, s43, 10485760
    s_cmp_lg_u32 s39, 0
    s_cbranch_scc1 L_fast_35
    buffer_store_dwordx4 v[240:243], v2, s[12:15], s43 offen sc1
    s_branch L_fdone_36
L_fast_35:
    buffer_store_dwordx4 v[240:243], v2, s[12:15], s43 offen
L_fdone_36:
    v_exp_f32 v10, v10
    v_exp_f32 v11, v11
    v_exp_f32 v12, v12
    v_exp_f32 v13, v13
    v_exp_f32 v14, v14
    s_waitcnt lgkmcnt(2)
    v_mfma_f32_32x32x16_bf16 v[24:39], v[60:63], v[4:7], 0
    ds_read_b128 v[56:59], v81 offset:45056
    v_exp_f32 v15, v15
    v_exp_f32 v16, v16
    v_exp_f32 v17, v17
    v_exp_f32 v18, v18
    v_exp_f32 v19, v19
    s_waitcnt lgkmcnt(2)
    v_smfmac_f32_32x32x32_bf16 v[40:55], v[64:67], v[8:15], v80
    s_mov_b64 exec, s[48:49]
    ds_read_b128 v[72:75], v82 offset:43008
    ds_read_b128 v[76:79], v82 offset:43520
    s_mov_b64 exec, -1
    buffer_load_dwordx4 v[116:119], v85, s[12:15], s51 offen offset:2048
    v_exp_f32 v20, v20
    v_exp_f32 v21, v21
    v_exp_f32 v22, v22
    v_exp_f32 v23, v23
    v_exp_f32 v24, v24
    v_exp_f32 v25, v25
    s_waitcnt lgkmcnt(3)
    v_smfmac_f32_32x32x32_bf16 v[40:55], v[68:71], v[16:23], v80
    buffer_load_dwordx4 v[120:123], v86, s[12:15], s51 offen offset:2048
    s_add_u32 s51, s51, 4096
    v_exp_f32 v26, v26
    v_exp_f32 v27, v27
    v_exp_f32 v28, v28
    v_exp_f32 v29, v29
    v_exp_f32 v30, v30
    s_waitcnt lgkmcnt(2)
    v_mfma_f32_32x32x16_bf16 v[8:23], v[56:59], v[4:7], 0
    ds_read_b128 v[60:63], v81 offset:47104
    v_exp_f32 v31, v31
    v_exp_f32 v32, v32
    v_exp_f32 v33, v33
    v_exp_f32 v34, v34
    v_exp_f32 v35, v35
    s_waitcnt lgkmcnt(2)
    v_smfmac_f32_32x32x32_bf16 v[40:55], v[72:75], v[24:31], v80
    s_mov_b64 exec, s[48:49]
    ds_read_b128 v[64:67], v82 offset:45056
    ds_read_b128 v[68:71], v82 offset:45568
    s_mov_b64 exec, -1
    v_exp_f32 v36, v36
    v_exp_f32 v37, v37
    v_exp_f32 v38, v38
    v_exp_f32 v39, v39
    v_exp_f32 v8, v8
    v_exp_f32 v9, v9
    s_waitcnt lgkmcnt(3)
    v_smfmac_f32_32x32x32_bf16 v[40:55], v[76:79], v[32:39], v80
    buffer_load_dwordx4 v[124:127], v85, s[12:15], s51 offen offset:0
    v_exp_f32 v10, v10
    v_exp_f32 v11, v11
    v_exp_f32 v12, v12
    v_exp_f32 v13, v13
    v_exp_f32 v14, v14
    s_waitcnt lgkmcnt(2)
    v_mfma_f32_32x32x16_bf16 v[24:39], v[60:63], v[4:7], 0
    ds_read_b128 v[56:59], v81 offset:49152
    v_exp_f32 v15, v15
    v_exp_f32 v16, v16
    v_exp_f32 v17, v17
    v_exp_f32 v18, v18
    v_exp_f32 v19, v19
    s_waitcnt lgkmcnt(2)
    v_smfmac_f32_32x32x32_bf16 v[40:55], v[64:67], v[8:15], v80
    s_mov_b64 exec, s[48:49]
    ds_read_b128 v[72:75], v82 offset:47104
    ds_read_b128 v[76:79], v82 offset:47616
    s_mov_b64 exec, -1
    v_exp_f32 v20, v20
    v_exp_f32 v21, v21
    v_exp_f32 v22, v22
    v_exp_f32 v23, v23
    v_exp_f32 v24, v24
    v_exp_f32 v25, v25
    s_waitcnt lgkmcnt(3)
    v_smfmac_f32_32x32x32_bf16 v[40:55], v[68:71], v[16:23], v80
    buffer_load_dwordx4 v[128:131], v86, s[12:15], s51 offen offset:0
    v_exp_f32 v26, v26
    v_exp_f32 v27, v27
    v_exp_f32 v28, v28
    v_exp_f32 v29, v29
    v_exp_f32 v30, v30
    s_waitcnt lgkmcnt(2)
    v_mfma_f32_32x32x16_bf16 v[8:23], v[56:59], v[4:7], 0
    ds_read_b128 v[60:63], v81 offset:51200
    v_exp_f32 v31, v31
    v_exp_f32 v32, v32
    v_exp_f32 v33, v33
    v_exp_f32 v34, v34
    v_exp_f32 v35, v35
    s_waitcnt lgkmcnt(2)
    v_smfmac_f32_32x32x32_bf16 v[40:55], v[72:75], v[24:31], v80
    s_mov_b64 exec, s[48:49]
    ds_read_b128 v[64:67], v82 offset:49152
    ds_read_b128 v[68:71], v82 offset:49664
    s_mov_b64 exec, -1
    v_exp_f32 v36, v36
    v_exp_f32 v37, v37
    v_exp_f32 v38, v38
    v_exp_f32 v39, v39
    s_barrier
    v_exp_f32 v8, v8
    v_exp_f32 v9, v9
    s_waitcnt lgkmcnt(3)
    v_smfmac_f32_32x32x32_bf16 v[40:55], v[76:79], v[32:39], v80
    s_add_u32 m0, s54, 0
    s_add_u32 s50, s53, 0
    buffer_load_dwordx4 v2, s[12:15], s50 offen offset:0 lds
    v_exp_f32 v10, v10
    v_exp_f32 v11, v11
    v_exp_f32 v12, v12
    v_exp_f32 v13, v13
    v_exp_f32 v14, v14
    s_waitcnt lgkmcnt(2)
    v_mfma_f32_32x32x16_bf16 v[24:39], v[60:63], v[4:7], 0
    ds_read_b128 v[56:59], v81 offset:53248
    v_exp_f32 v15, v15
    v_exp_f32 v16, v16
    v_exp_f32 v17, v17
    v_exp_f32 v18, v18
    v_exp_f32 v19, v19
    s_waitcnt lgkmcnt(2)
    v_smfmac_f32_32x32x32_bf16 v[40:55], v[64:67], v[8:15], v80
    s_mov_b64 exec, s[48:49]
    ds_read_b128 v[72:75], v82 offset:51200
    ds_read_b128 v[76:79], v82 offset:51712
    s_mov_b64 exec, -1
    buffer_load_dwordx4 v[132:135], v85, s[12:15], s51 offen offset:2048
    v_exp_f32 v20, v20
    v_exp_f32 v21, v21
    v_exp_f32 v22, v22
    v_exp_f32 v23, v23
    v_exp_f32 v24, v24
    v_exp_f32 v25, v25
    s_waitcnt lgkmcnt(3)
    v_smfmac_f32_32x32x32_bf16 v[40:55], v[68:71], v[16:23], v80
    buffer_load_dwordx4 v[136:139], v86, s[12:15], s51 offen offset:2048
    s_add_u32 s51, s51, 4096
    v_exp_f32 v26, v26
    v_exp_f32 v27, v27
    v_exp_f32 v28, v28
    v_exp_f32 v29, v29
    v_exp_f32 v30, v30
    s_waitcnt lgkmcnt(2)
    v_mfma_f32_32x32x16_bf16 v[8:23], v[56:59], v[4:7], 0
    ds_read_b128 v[60:63], v81 offset:55296
    v_exp_f32 v31, v31
    v_exp_f32 v32, v32
    v_exp_f32 v33, v33
    v_exp_f32 v34, v34
    v_exp_f32 v35, v35
    s_waitcnt lgkmcnt(2)
    v_smfmac_f32_32x32x32_bf16 v[40:55], v[72:75], v[24:31], v80
    s_mov_b64 exec, s[48:49]
    ds_read_b128 v[64:67], v82 offset:53248
    ds_read_b128 v[68:71], v82 offset:53760
    s_mov_b64 exec, -1
    v_exp_f32 v36, v36
    v_exp_f32 v37, v37
    v_exp_f32 v38, v38
    v_exp_f32 v39, v39
    v_exp_f32 v8, v8
    v_exp_f32 v9, v9
    s_waitcnt lgkmcnt(3)
    v_smfmac_f32_32x32x32_bf16 v[40:55], v[76:79], v[32:39], v80
    s_lshl_b32 s42, s37, 2
    s_and_b32 s43, s3, 3
    s_add_u32 s42, s42, s43
    s_lshl_b32 s42, s42, 1
    s_lshr_b32 s43, s3, 2
    s_add_u32 s42, s42, s43
    s_mul_i32 s42, s42, 86
    s_mul_i32 s43, s38, 3
    s_add_u32 s42, s42, s43
    s_lshl_b32 s42, s42, 10
    s_add_u32 s42, s42, 12582912
    s_cmp_ge_u32 s38, 29
    s_cselect_b32 s42, 1073741824, s42
    s_cmp_ge_u32 s38, 28
    s_cselect_b32 s43, 1073741824, s42
    s_cmp_lg_u32 s39, 0
    s_cbranch_scc1 L_fast_37
    buffer_store_dwordx4 v[240:243], v2, s[12:15], s42 offen offset:0 sc1
    s_branch L_fdone_38
L_fast_37:
    buffer_store_dwordx4 v[240:243], v2, s[12:15], s42 offen offset:0
L_fdone_38:
    v_exp_f32 v10, v10
    v_exp_f32 v11, v11
    v_exp_f32 v12, v12
    v_exp_f32 v13, v13
    v_exp_f32 v14, v14
    s_waitcnt lgkmcnt(2)
    v_mfma_f32_32x32x16_bf16 v[24:39], v[60:63], v[4:7], 0
    ds_read_b128 v[56:59], v81 offset:57344
    v_exp_f32 v15, v15
    v_exp_f32 v16, v16
    v_exp_f32 v17, v17
    v_exp_f32 v18, v18
    v_exp_f32 v19, v19
    s_waitcnt lgkmcnt(2)
    v_smfmac_f32_32x32x32_bf16 v[40:55], v[64:67], v[8:15], v80
    s_mov_b64 exec, s[48:49]
    ds_read_b128 v[72:75], v82 offset:55296
    ds_read_b128 v[76:79], v82 offset:55808
    s_mov_b64 exec, -1
    buffer_load_dwordx4 v[140:143], v85, s[12:15], s51 offen offset:0
    v_exp_f32 v20, v20
    v_exp_f32 v21, v21
    v_exp_f32 v22, v22
    v_exp_f32 v23, v23
    v_exp_f32 v24, v24
    v_exp_f32 v25, v25
    s_waitcnt lgkmcnt(3)
    v_smfmac_f32_32x32x32_bf16 v[40:55], v[68:71], v[16:23], v80
    buffer_load_dwordx4 v[144:147], v86, s[12:15], s51 offen offset:0
    v_exp_f32 v26, v26
    v_exp_f32 v27, v27
    v_exp_f32 v28, v28
    v_exp_f32 v29, v29
    v_exp_f32 v30, v30
    s_waitcnt lgkmcnt(2)
    v_mfma_f32_32x32x16_bf16 v[8:23], v[56:59], v[4:7], 0
    ds_read_b128 v[60:63], v81 offset:59392
    v_exp_f32 v31, v31
    v_exp_f32 v32, v32
    v_exp_f32 v33, v33
    v_exp_f32 v34, v34
    v_exp_f32 v35, v35
    s_waitcnt lgkmcnt(2)
    v_smfmac_f32_32x32x32_bf16 v[40:55], v[72:75], v[24:31], v80
    s_mov_b64 exec, s[48:49]
    ds_read_b128 v[64:67], v82 offset:57344
    ds_read_b128 v[68:71], v82 offset:57856
    s_mov_b64 exec, -1
    buffer_load_dwordx4 v2, s[12:15], s50 offen offset:1024 lds
    v_exp_f32 v36, v36
    v_exp_f32 v37, v37
    v_exp_f32 v38, v38
    v_exp_f32 v39, v39
    v_exp_f32 v8, v8
    v_exp_f32 v9, v9
    s_waitcnt lgkmcnt(3)
    v_smfmac_f32_32x32x32_bf16 v[40:55], v[76:79], v[32:39], v80
    buffer_load_dwordx4 v[148:151], v85, s[12:15], s51 offen offset:2048
    v_exp_f32 v10, v10
    v_exp_f32 v11, v11
    v_exp_f32 v12, v12
    v_exp_f32 v13, v13
    v_exp_f32 v14, v14
    s_waitcnt lgkmcnt(2)
    v_mfma_f32_32x32x16_bf16 v[24:39], v[60:63], v[4:7], 0
    ds_read_b128 v[56:59], v81 offset:61440
    v_exp_f32 v15, v15
    v_exp_f32 v16, v16
    v_exp_f32 v17, v17
    v_exp_f32 v18, v18
    v_exp_f32 v19, v19
    s_waitcnt lgkmcnt(2)
    v_smfmac_f32_32x32x32_bf16 v[40:55], v[64:67], v[8:15], v80
    s_mov_b64 exec, s[48:49]
    ds_read_b128 v[72:75], v82 offset:59392
    ds_read_b128 v[76:79], v82 offset:59904
    s_mov_b64 exec, -1
    v_exp_f32 v20, v20
    v_exp_f32 v21, v21
    v_exp_f32 v22, v22
    v_exp_f32 v23, v23
    v_exp_f32 v24, v24
    v_exp_f32 v25, v25
    s_waitcnt lgkmcnt(3)
    v_smfmac_f32_32x32x32_bf16 v[40:55], v[68:71], v[16:23], v80
    buffer_load_dwordx4 v[152:155], v86, s[12:15], s51 offen offset:2048
    s_add_u32 s51, s51, 4096
    v_exp_f32 v26, v26
    v_exp_f32 v27, v27
    v_exp_f32 v28, v28
    v_exp_f32 v29, v29
    v_exp_f32 v30, v30
    s_waitcnt lgkmcnt(2)
    v_mfma_f32_32x32x16_bf16 v[8:23], v[56:59], v[4:7], 0
    ds_read_b128 v[60:63], v81 offset:63488
    v_exp_f32 v31, v31
    v_exp_f32 v32, v32
    v_exp_f32 v33, v33
    v_exp_f32 v34, v34
    v_exp_f32 v35, v35
    s_waitcnt lgkmcnt(2)
    v_smfmac_f32_32x32x32_bf16 v[40:55], v[72:75], v[24:31], v80
    s_mov_b64 exec, s[48:49]
    ds_read_b128 v[64:67], v82 offset:61440
    ds_read_b128 v[68:71], v82 offset:61952
    s_mov_b64 exec, -1
    v_exp_f32 v36, v36
    v_exp_f32 v37, v37
    v_exp_f32 v38, v38
    v_exp_f32 v39, v39
    v_exp_f32 v8, v8
    v_exp_f32 v9, v9
    s_waitcnt lgkmcnt(3)
    v_smfmac_f32_32x32x32_bf16 v[40:55], v[76:79], v[32:39], v80
    buffer_load_dwordx4 v[156:159], v85, s[12:15], s52 offen offset:0
    v_exp_f32 v10, v10
    v_exp_f32 v11, v11
    v_exp_f32 v12, v12
    v_exp_f32 v13, v13
    v_exp_f32 v14, v14
    s_waitcnt lgkmcnt(2)
    v_mfma_f32_32x32x16_bf16 v[24:39], v[60:63], v[4:7], 0
    ds_read_b128 v[56:59], v83 offset:0
    v_exp_f32 v15, v15
    v_exp_f32 v16, v16
    v_exp_f32 v17, v17
    v_exp_f32 v18, v18
    v_exp_f32 v19, v19
    s_waitcnt lgkmcnt(2)
    v_smfmac_f32_32x32x32_bf16 v[40:55], v[64:67], v[8:15], v80
    s_mov_b64 exec, s[48:49]
    ds_read_b128 v[72:75], v82 offset:63488
    ds_read_b128 v[76:79], v82 offset:64000
    s_mov_b64 exec, -1
    v_exp_f32 v20, v20
    v_exp_f32 v21, v21
    v_exp_f32 v22, v22
    v_exp_f32 v23, v23
    v_exp_f32 v24, v24
    v_exp_f32 v25, v25
    s_waitcnt lgkmcnt(3)
    v_smfmac_f32_32x32x32_bf16 v[40:55], v[68:71], v[16:23], v80
    v_exp_f32 v26, v26
    v_exp_f32 v27, v27
    v_exp_f32 v28, v28
    v_exp_f32 v29, v29
    v_exp_f32 v30, v30
    s_waitcnt lgkmcnt(2)
    v_mfma_f32_32x32x16_bf16 v[8:23], v[56:59], v[4:7], 0
    ds_read_b128 v[60:63], v83 offset:2048
    v_exp_f32 v31, v31
    v_exp_f32 v32, v32
    v_exp_f32 v33, v33
    v_exp_f32 v34, v34
    v_exp_f32 v35, v35
    s_waitcnt lgkmcnt(2)
    v_smfmac_f32_32x32x32_bf16 v[40:55], v[72:75], v[24:31], v80
    s_mov_b64 exec, s[48:49]
    ds_read_b128 v[64:67], v84 offset:0
    ds_read_b128 v[68:71], v84 offset:512
    s_mov_b64 exec, -1
    buffer_load_dwordx4 v2, s[12:15], s50 offen offset:2048 lds
    v_exp_f32 v36, v36
    v_exp_f32 v37, v37
    v_exp_f32 v38, v38
    v_exp_f32 v39, v39
    v_exp_f32 v8, v8
    v_exp_f32 v9, v9
    s_waitcnt lgkmcnt(3)
    v_smfmac_f32_32x32x32_bf16 v[40:55], v[76:79], v[32:39], v80
    s_lshl_b32 s42, s37, 2
    s_and_b32 s43, s3, 3
    s_add_u32 s42, s42, s43
    s_lshl_b32 s42, s42, 1
    s_lshr_b32 s43, s3, 2
    s_add_u32 s42, s42, s43
    s_mul_i32 s42, s42, 86
    s_mul_i32 s43, s38, 3
    s_add_u32 s42, s42, s43
    s_lshl_b32 s42, s42, 10
    s_add_u32 s42, s42, 12582912
    s_cmp_ge_u32 s38, 29
    s_cselect_b32 s42, 1073741824, s42
    s_cmp_ge_u32 s38, 28
    s_cselect_b32 s43, 1073741824, s42
    s_cmp_lg_u32 s39, 0
    s_cbranch_scc1 L_fast_39
    buffer_store_dwordx4 v[240:243], v2, s[12:15], s42 offen offset:1024 sc1
    s_branch L_fdone_40
L_fast_39:
    buffer_store_dwordx4 v[240:243], v2, s[12:15], s42 offen offset:1024
L_fdone_40:
    v_exp_f32 v10, v10
    v_exp_f32 v11, v11
    v_exp_f32 v12, v12
    v_exp_f32 v13, v13
    v_exp_f32 v14, v14
    s_waitcnt lgkmcnt(2)
    v_mfma_f32_32x32x16_bf16 v[24:39], v[60:63], v[4:7], 0
    ds_read_b128 v[56:59], v83 offset:4096
    v_exp_f32 v15, v15
    v_exp_f32 v16, v16
    v_exp_f32 v17, v17
    v_exp_f32 v18, v18
    v_exp_f32 v19, v19
    s_waitcnt lgkmcnt(2)
    v_smfmac_f32_32x32x32_bf16 v[40:55], v[64:67], v[8:15], v80
    s_mov_b64 exec, s[48:49]
    ds_read_b128 v[72:75], v84 offset:2048
    ds_read_b128 v[76:79], v84 offset:2560
    s_mov_b64 exec, -1
    buffer_load_dwordx4 v[160:163], v86, s[12:15], s52 offen offset:0
    v_exp_f32 v20, v20
    v_exp_f32 v21, v21
    v_exp_f32 v22, v22
    v_exp_f32 v23, v23
    v_exp_f32 v24, v24
    v_exp_f32 v25, v25
    s_waitcnt lgkmcnt(3)
    v_smfmac_f32_32x32x32_bf16 v[40:55], v[68:71], v[16:23], v80
    buffer_load_dwordx4 v[164:167], v85, s[12:15], s52 offen offset:2048
    v_exp_f32 v26, v26
    v_exp_f32 v27, v27
    v_exp_f32 v28, v28
    v_exp_f32 v29, v29
    v_exp_f32 v30, v30
    s_waitcnt lgkmcnt(2)
    v_mfma_f32_32x32x16_bf16 v[8:23], v[56:59], v[4:7], 0
    ds_read_b128 v[60:63], v83 offset:6144
    v_exp_f32 v31, v31
    v_exp_f32 v32, v32
    v_exp_f32 v33, v33
    v_exp_f32 v34, v34
    v_exp_f32 v35, v35
    s_waitcnt lgkmcnt(2)
    v_smfmac_f32_32x32x32_bf16 v[40:55], v[72:75], v[24:31], v80
    s_mov_b64 exec, s[48:49]
    ds_read_b128 v[64:67], v84 offset:4096
    ds_read_b128 v[68:71], v84 offset:4608
    s_mov_b64 exec, -1
    buffer_load_dwordx4 v[168:171], v86, s[12:15], s52 offen offset:2048
    s_add_u32 s52, s52, 4096
    v_exp_f32 v36, v36
    v_exp_f32 v37, v37
    v_exp_f32 v38, v38
    v_exp_f32 v39, v39
    v_exp_f32 v8, v8
    v_exp_f32 v9, v9
    s_waitcnt lgkmcnt(3)
    v_smfmac_f32_32x32x32_bf16 v[40:55], v[76:79], v[32:39], v80
    v_exp_f32 v10, v10
    v_exp_f32 v11, v11
    v_exp_f32 v12, v12
    v_exp_f32 v13, v13
    v_exp_f32 v14, v14
    s_waitcnt lgkmcnt(2)
    v_mfma_f32_32x32x16_bf16 v[24:39], v[60:63], v[4:7], 0
    ds_read_b128 v[56:59], v83 offset:8192
    v_exp_f32 v15, v15
    v_exp_f32 v16, v16
    v_exp_f32 v17, v17
    v_exp_f32 v18, v18
    v_exp_f32 v19, v19
    s_waitcnt lgkmcnt(2)
    v_smfmac_f32_32x32x32_bf16 v[40:55], v[64:67], v[8:15], v80
    s_mov_b64 exec, s[48:49]
    ds_read_b128 v[72:75], v84 offset:6144
    ds_read_b128 v[76:79], v84 offset:6656
    s_mov_b64 exec, -1
    buffer_load_dwordx4 v[172:175], v85, s[12:15], s52 offen offset:0
    v_exp_f32 v20, v20
    v_exp_f32 v21, v21
    v_exp_f32 v22, v22
    v_exp_f32 v23, v23
    v_exp_f32 v24, v24
    v_exp_f32 v25, v25
    s_waitcnt lgkmcnt(3)
    v_smfmac_f32_32x32x32_bf16 v[40:55], v[68:71], v[16:23], v80
    v_exp_f32 v26, v26
    v_exp_f32 v27, v27
    v_exp_f32 v28, v28
    v_exp_f32 v29, v29
    v_exp_f32 v30, v30
    s_waitcnt lgkmcnt(2)
    v_mfma_f32_32x32x16_bf16 v[8:23], v[56:59], v[4:7], 0
    ds_read_b128 v[60:63], v83 offset:10240
    v_exp_f32 v31, v31
    v_exp_f32 v32, v32
    v_exp_f32 v33, v33
    v_exp_f32 v34, v34
    v_exp_f32 v35, v35
    s_waitcnt lgkmcnt(2)
    v_smfmac_f32_32x32x32_bf16 v[40:55], v[72:75], v[24:31], v80
    s_mov_b64 exec, s[48:49]
    ds_read_b128 v[64:67], v84 offset:8192
    ds_read_b128 v[68:71], v84 offset:8704
    s_mov_b64 exec, -1
    buffer_load_dwordx4 v2, s[12:15], s50 offen offset:3072 lds
    v_exp_f32 v36, v36
    v_exp_f32 v37, v37
    v_exp_f32 v38, v38
    v_exp_f32 v39, v39
    v_exp_f32 v8, v8
    v_exp_f32 v9, v9
    s_waitcnt lgkmcnt(3)
    v_smfmac_f32_32x32x32_bf16 v[40:55], v[76:79], v[32:39], v80
    buffer_load_dwordx4 v[176:179], v86, s[12:15], s52 offen offset:0
    v_exp_f32 v10, v10
    v_exp_f32 v11, v11
    v_exp_f32 v12, v12
    v_exp_f32 v13, v13
    v_exp_f32 v14, v14
    s_waitcnt lgkmcnt(2)
    v_mfma_f32_32x32x16_bf16 v[24:39], v[60:63], v[4:7], 0
    ds_read_b128 v[56:59], v83 offset:12288
    v_exp_f32 v15, v15
    v_exp_f32 v16, v16
    v_exp_f32 v17, v17
    v_exp_f32 v18, v18
    v_exp_f32 v19, v19
    s_waitcnt lgkmcnt(2)
    v_smfmac_f32_32x32x32_bf16 v[40:55], v[64:67], v[8:15], v80
    s_mov_b64 exec, s[48:49]
    ds_read_b128 v[72:75], v84 offset:10240
    ds_read_b128 v[76:79], v84 offset:10752
    s_mov_b64 exec, -1
    buffer_load_dwordx4 v[180:183], v85, s[12:15], s52 offen offset:2048
    v_exp_f32 v20, v20
    v_exp_f32 v21, v21
    v_exp_f32 v22, v22
    v_exp_f32 v23, v23
    v_exp_f32 v24, v24
    v_exp_f32 v25, v25
    s_waitcnt lgkmcnt(3)
    v_smfmac_f32_32x32x32_bf16 v[40:55], v[68:71], v[16:23], v80
    v_exp_f32 v26, v26
    v_exp_f32 v27, v27
    v_exp_f32 v28, v28
    v_exp_f32 v29, v29
    v_exp_f32 v30, v30
    s_waitcnt lgkmcnt(2)
    v_mfma_f32_32x32x16_bf16 v[8:23], v[56:59], v[4:7], 0
    ds_read_b128 v[60:63], v83 offset:14336
    v_exp_f32 v31, v31
    v_exp_f32 v32, v32
    v_exp_f32 v33, v33
    v_exp_f32 v34, v34
    v_exp_f32 v35, v35
    s_waitcnt lgkmcnt(2)
    v_smfmac_f32_32x32x32_bf16 v[40:55], v[72:75], v[24:31], v80
    s_mov_b64 exec, s[48:49]
    ds_read_b128 v[64:67], v84 offset:12288
    ds_read_b128 v[68:71], v84 offset:12800
    s_mov_b64 exec, -1
    buffer_load_dwordx4 v[184:187], v86, s[12:15], s52 offen offset:2048
    s_add_u32 s52, s52, 4096
    v_exp_f32 v36, v36
    v_exp_f32 v37, v37
    v_exp_f32 v38, v38
    v_exp_f32 v39, v39
    v_exp_f32 v8, v8
    v_exp_f32 v9, v9
    s_waitcnt lgkmcnt(3)
    v_smfmac_f32_32x32x32_bf16 v[40:55], v[76:79], v[32:39], v80
    s_lshl_b32 s42, s37, 2
    s_and_b32 s43, s3, 3
    s_add_u32 s42, s42, s43
    s_lshl_b32 s42, s42, 1
    s_lshr_b32 s43, s3, 2
    s_add_u32 s42, s42, s43
    s_mul_i32 s42, s42, 86
    s_mul_i32 s43, s38, 3
    s_add_u32 s42, s42, s43
    s_lshl_b32 s42, s42, 10
    s_add_u32 s42, s42, 12582912
    s_cmp_ge_u32 s38, 29
    s_cselect_b32 s42, 1073741824, s42
    s_cmp_ge_u32 s38, 28
    s_cselect_b32 s43, 1073741824, s42
    s_cmp_lg_u32 s39, 0
    s_cbranch_scc1 L_fast_41
    buffer_store_dwordx4 v[240:243], v2, s[12:15], s43 offen offset:2048 sc1
    s_branch L_fdone_42
L_fast_41:
    buffer_store_dwordx4 v[240:243], v2, s[12:15], s43 offen offset:2048
L_fdone_42:
    v_exp_f32 v10, v10
    v_exp_f32 v11, v11
    v_exp_f32 v12, v12
    v_exp_f32 v13, v13
    v_exp_f32 v14, v14
    s_waitcnt lgkmcnt(2)
    v_mfma_f32_32x32x16_bf16 v[24:39], v[60:63], v[4:7], 0
    ds_read_b128 v[56:59], v83 offset:16384
    v_exp_f32 v15, v15
    v_exp_f32 v16, v16
    v_exp_f32 v17, v17
    v_exp_f32 v18, v18
    v_exp_f32 v19, v19
    s_waitcnt lgkmcnt(2)
    v_smfmac_f32_32x32x32_bf16 v[40:55], v[64:67], v[8:15], v80
    s_mov_b64 exec, s[48:49]
    ds_read_b128 v[72:75], v84 offset:14336
    ds_read_b128 v[76:79], v84 offset:14848
    s_mov_b64 exec, -1
    buffer_load_dwordx4 v[188:191], v85, s[12:15], s52 offen offset:0
    v_exp_f32 v20, v20
    v_exp_f32 v21, v21
    v_exp_f32 v22, v22
    v_exp_f32 v23, v23
    v_exp_f32 v24, v24
    v_exp_f32 v25, v25
    s_waitcnt lgkmcnt(3)
    v_smfmac_f32_32x32x32_bf16 v[40:55], v[68:71], v[16:23], v80
    s_add_u32 m0, s54, 4096
    s_add_u32 s50, s53, 4096
    buffer_load_dwordx4 v2, s[12:15], s50 offen offset:0 lds
    v_exp_f32 v26, v26
    v_exp_f32 v27, v27
    v_exp_f32 v28, v28
    v_exp_f32 v29, v29
    v_exp_f32 v30, v30
    s_waitcnt lgkmcnt(2)
    v_mfma_f32_32x32x16_bf16 v[8:23], v[56:59], v[4:7], 0
    ds_read_b128 v[60:63], v83 offset:18432
    v_exp_f32 v31, v31
    v_exp_f32 v32, v32
    v_exp_f32 v33, v33
    v_exp_f32 v34, v34
    v_exp_f32 v35, v35
    s_waitcnt lgkmcnt(2)
    v_smfmac_f32_32x32x32_bf16 v[40:55], v[72:75], v[24:31], v80
    s_mov_b64 exec, s[48:49]
    ds_read_b128 v[64:67], v84 offset:16384
    ds_read_b128 v[68:71], v84 offset:16896
    s_mov_b64 exec, -1
    buffer_load_dwordx4 v[192:195], v86, s[12:15], s52 offen offset:0
    v_exp_f32 v36, v36
    v_exp_f32 v37, v37
    v_exp_f32 v38, v38
    v_exp_f32 v39, v39
    v_exp_f32 v8, v8
    v_exp_f32 v9, v9
    s_waitcnt lgkmcnt(3)
    v_smfmac_f32_32x32x32_bf16 v[40:55], v[76:79], v[32:39], v80
    v_exp_f32 v10, v10
    v_exp_f32 v11, v11
    v_exp_f32 v12, v12
    v_exp_f32 v13, v13
    v_exp_f32 v14, v14
    s_waitcnt lgkmcnt(2)
    v_mfma_f32_32x32x16_bf16 v[24:39], v[60:63], v[4:7], 0
    ds_read_b128 v[56:59], v83 offset:20480
    v_exp_f32 v15, v15
    v_exp_f32 v16, v16
    v_exp_f32 v17, v17
    v_exp_f32 v18, v18
    v_exp_f32 v19, v19
    s_waitcnt lgkmcnt(2)
    v_smfmac_f32_32x32x32_bf16 v[40:55], v[64:67], v[8:15], v80
    s_mov_b64 exec, s[48:49]
    ds_read_b128 v[72:75], v84 offset:18432
    ds_read_b128 v[76:79], v84 offset:18944
    s_mov_b64 exec, -1
    buffer_load_dwordx4 v[196:199], v85, s[12:15], s52 offen offset:2048
    v_exp_f32 v20, v20
    v_exp_f32 v21, v21
    v_exp_f32 v22, v22
    v_exp_f32 v23, v23
    v_exp_f32 v24, v24
    v_exp_f32 v25, v25
    s_waitcnt lgkmcnt(3)
    v_smfmac_f32_32x32x32_bf16 v[40:55], v[68:71], v[16:23], v80
    v_exp_f32 v26, v26
    v_exp_f32 v27, v27
    v_exp_f32 v28, v28
    v_exp_f32 v29, v29
    v_exp_f32 v30, v30
    s_waitcnt lgkmcnt(2)
    v_mfma_f32_32x32x16_bf16 v[8:23], v[56:59], v[4:7], 0
    ds_read_b128 v[60:63], v83 offset:22528
    v_exp_f32 v31, v31
    v_exp_f32 v32, v32
    v_exp_f32 v33, v33
    v_exp_f32 v34, v34
    v_exp_f32 v35, v35
    s_waitcnt lgkmcnt(2)
    v_smfmac_f32_32x32x32_bf16 v[40:55], v[72:75], v[24:31], v80
    s_mov_b64 exec, s[48:49]
    ds_read_b128 v[64:67], v84 offset:20480
    ds_read_b128 v[68:71], v84 offset:20992
    s_mov_b64 exec, -1
    buffer_load_dwordx4 v[200:203], v86, s[12:15], s52 offen offset:2048
    s_add_u32 s52, s52, 4096
    v_exp_f32 v36, v36
    v_exp_f32 v37, v37
    v_exp_f32 v38, v38
    v_exp_f32 v39, v39
    v_exp_f32 v8, v8
    v_exp_f32 v9, v9
    s_waitcnt lgkmcnt(3)
    v_smfmac_f32_32x32x32_bf16 v[40:55], v[76:79], v[32:39], v80
    v_exp_f32 v10, v10
    v_exp_f32 v11, v11
    v_exp_f32 v12, v12
    v_exp_f32 v13, v13
    v_exp_f32 v14, v14
    s_waitcnt lgkmcnt(2)
    v_mfma_f32_32x32x16_bf16 v[24:39], v[60:63], v[4:7], 0
    ds_read_b128 v[56:59], v83 offset:24576
    v_exp_f32 v15, v15
    v_exp_f32 v16, v16
    v_exp_f32 v17, v17
    v_exp_f32 v18, v18
    v_exp_f32 v19, v19
    s_waitcnt lgkmcnt(2)
    v_smfmac_f32_32x32x32_bf16 v[40:55], v[64:67], v[8:15], v80
    s_mov_b64 exec, s[48:49]
    ds_read_b128 v[72:75], v84 offset:22528
    ds_read_b128 v[76:79], v84 offset:23040
    s_mov_b64 exec, -1
    buffer_load_dwordx4 v[204:207], v85, s[12:15], s52 offen offset:0
    v_exp_f32 v20, v20
    v_exp_f32 v21, v21
    v_exp_f32 v22, v22
    v_exp_f32 v23, v23
    v_exp_f32 v24, v24
    v_exp_f32 v25, v25
    s_waitcnt lgkmcnt(3)
    v_smfmac_f32_32x32x32_bf16 v[40:55], v[68:71], v[16:23], v80
    buffer_load_dwordx4 v2, s[12:15], s50 offen offset:1024 lds
    v_exp_f32 v26, v26
    v_exp_f32 v27, v27
    v_exp_f32 v28, v28
    v_exp_f32 v29, v29
    v_exp_f32 v30, v30
    s_waitcnt lgkmcnt(2)
    v_mfma_f32_32x32x16_bf16 v[8:23], v[56:59], v[4:7], 0
    ds_read_b128 v[60:63], v83 offset:26624
    v_exp_f32 v31, v31
    v_exp_f32 v32, v32
    v_exp_f32 v33, v33
    v_exp_f32 v34, v34
    v_exp_f32 v35, v35
    s_waitcnt lgkmcnt(2)
    v_smfmac_f32_32x32x32_bf16 v[40:55], v[72:75], v[24:31], v80
    s_mov_b64 exec, s[48:49]
    ds_read_b128 v[64:67], v84 offset:24576
    ds_read_b128 v[68:71], v84 offset:25088
    s_mov_b64 exec, -1
    buffer_load_dwordx4 v[208:211], v86, s[12:15], s52 offen offset:0
    v_exp_f32 v36, v36
    v_exp_f32 v37, v37
    v_exp_f32 v38, v38
    v_exp_f32 v39, v39
    v_exp_f32 v8, v8
    v_exp_f32 v9, v9
    s_waitcnt lgkmcnt(3)
    v_smfmac_f32_32x32x32_bf16 v[40:55], v[76:79], v[32:39], v80
    v_exp_f32 v10, v10
    v_exp_f32 v11, v11
    v_exp_f32 v12, v12
    v_exp_f32 v13, v13
    v_exp_f32 v14, v14
    s_waitcnt lgkmcnt(2)
    v_mfma_f32_32x32x16_bf16 v[24:39], v[60:63], v[4:7], 0
    ds_read_b128 v[56:59], v83 offset:28672
    v_exp_f32 v15, v15
    v_exp_f32 v16, v16
    v_exp_f32 v17, v17
    v_exp_f32 v18, v18
    v_exp_f32 v19, v19
    s_waitcnt lgkmcnt(2)
    v_smfmac_f32_32x32x32_bf16 v[40:55], v[64:67], v[8:15], v80
    s_mov_b64 exec, s[48:49]
    ds_read_b128 v[72:75], v84 offset:26624
    ds_read_b128 v[76:79], v84 offset:27136
    s_mov_b64 exec, -1
    buffer_load_dwordx4 v[212:215], v85, s[12:15], s52 offen offset:2048
    v_exp_f32 v20, v20
    v_exp_f32 v21, v21
    v_exp_f32 v22, v22
    v_exp_f32 v23, v23
    v_exp_f32 v24, v24
    v_exp_f32 v25, v25
    s_waitcnt lgkmcnt(3)
    v_smfmac_f32_32x32x32_bf16 v[40:55], v[68:71], v[16:23], v80
    v_exp_f32 v26, v26
    v_exp_f32 v27, v27
    v_exp_f32 v28, v28
    v_exp_f32 v29, v29
    v_exp_f32 v30, v30
    s_waitcnt lgkmcnt(2)
    v_mfma_f32_32x32x16_bf16 v[8:23], v[56:59], v[4:7], 0
    ds_read_b128 v[60:63], v83 offset:30720
    v_exp_f32 v31, v31
    v_exp_f32 v32, v32
    v_exp_f32 v33, v33
    v_exp_f32 v34, v34
    v_exp_f32 v35, v35
    s_waitcnt lgkmcnt(2)
    v_smfmac_f32_32x32x32_bf16 v[40:55], v[72:75], v[24:31], v80
    s_mov_b64 exec, s[48:49]
    ds_read_b128 v[64:67], v84 offset:28672
    ds_read_b128 v[68:71], v84 offset:29184
    s_mov_b64 exec, -1
    buffer_load_dwordx4 v[216:219], v86, s[12:15], s52 offen offset:2048
    s_add_u32 s52, s52, 4096
    v_exp_f32 v36, v36
    v_exp_f32 v37, v37
    v_exp_f32 v38, v38
    v_exp_f32 v39, v39
    v_exp_f32 v8, v8
    v_exp_f32 v9, v9
    s_waitcnt lgkmcnt(3)
    v_smfmac_f32_32x32x32_bf16 v[40:55], v[76:79], v[32:39], v80
    v_exp_f32 v10, v10
    v_exp_f32 v11, v11
    v_exp_f32 v12, v12
    v_exp_f32 v13, v13
    v_exp_f32 v14, v14
    s_waitcnt lgkmcnt(2)
    v_mfma_f32_32x32x16_bf16 v[24:39], v[60:63], v[4:7], 0
    ds_read_b128 v[56:59], v83 offset:32768
    v_exp_f32 v15, v15
    v_exp_f32 v16, v16
    v_exp_f32 v17, v17
    v_exp_f32 v18, v18
    v_exp_f32 v19, v19
    s_waitcnt lgkmcnt(2)
    v_smfmac_f32_32x32x32_bf16 v[40:55], v[64:67], v[8:15], v80
    s_mov_b64 exec, s[48:49]
    ds_read_b128 v[72:75], v84 offset:30720
    ds_read_b128 v[76:79], v84 offset:31232
    s_mov_b64 exec, -1
    buffer_load_dwordx4 v[220:223], v85, s[12:15], s52 offen offset:0
    v_exp_f32 v20, v20
    v_exp_f32 v21, v21
    v_exp_f32 v22, v22
    v_exp_f32 v23, v23
    v_exp_f32 v24, v24
    v_exp_f32 v25, v25
    s_waitcnt lgkmcnt(3)
    v_smfmac_f32_32x32x32_bf16 v[40:55], v[68:71], v[16:23], v80
    v_exp_f32 v26, v26
    v_exp_f32 v27, v27
    v_exp_f32 v28, v28
    v_exp_f32 v29, v29
    v_exp_f32 v30, v30
    s_waitcnt lgkmcnt(2)
    v_mfma_f32_32x32x16_bf16 v[8:23], v[56:59], v[4:7], 0
    ds_read_b128 v[60:63], v83 offset:34816
    v_exp_f32 v31, v31
    v_exp_f32 v32, v32
    v_exp_f32 v33, v33
    v_exp_f32 v34, v34
    v_exp_f32 v35, v35
    s_waitcnt lgkmcnt(2)
    v_smfmac_f32_32x32x32_bf16 v[40:55], v[72:75], v[24:31], v80
    s_mov_b64 exec, s[48:49]
    ds_read_b128 v[64:67], v84 offset:32768
    ds_read_b128 v[68:71], v84 offset:33280
    s_mov_b64 exec, -1
    v_exp_f32 v36, v36
    v_exp_f32 v37, v37
    v_exp_f32 v38, v38
    v_exp_f32 v39, v39
    s_waitcnt vmcnt(11)
    s_barrier
    v_exp_f32 v8, v8
    v_exp_f32 v9, v9
    s_waitcnt lgkmcnt(3)
    v_smfmac_f32_32x32x32_bf16 v[40:55], v[76:79], v[32:39], v80
    s_add_u32 m0, s54, 49152
    s_add_u32 s50, s53, 49152
    buffer_load_dwordx4 v2, s[12:15], s50 offen offset:0 lds
    v_exp_f32 v10, v10
    v_exp_f32 v11, v11
    v_exp_f32 v12, v12
    v_exp_f32 v13, v13
    v_exp_f32 v14, v14
    s_waitcnt lgkmcnt(2)
    v_mfma_f32_32x32x16_bf16 v[24:39], v[60:63], v[4:7], 0
    ds_read_b128 v[56:59], v83 offset:36864
    v_exp_f32 v15, v15
    v_exp_f32 v16, v16
    v_exp_f32 v17, v17
    v_exp_f32 v18, v18
    v_exp_f32 v19, v19
    s_waitcnt lgkmcnt(2)
    v_smfmac_f32_32x32x32_bf16 v[40:55], v[64:67], v[8:15], v80
    s_mov_b64 exec, s[48:49]
    ds_read_b128 v[72:75], v84 offset:34816
    ds_read_b128 v[76:79], v84 offset:35328
    s_mov_b64 exec, -1
    buffer_load_dwordx4 v[224:227], v86, s[12:15], s52 offen offset:0
    v_exp_f32 v20, v20
    v_exp_f32 v21, v21
    v_exp_f32 v22, v22
    v_exp_f32 v23, v23
    v_exp_f32 v24, v24
    v_exp_f32 v25, v25
    s_waitcnt lgkmcnt(3)
    v_smfmac_f32_32x32x32_bf16 v[40:55], v[68:71], v[16:23], v80
    v_exp_f32 v26, v26
    v_exp_f32 v27, v27
    v_exp_f32 v28, v28
    v_exp_f32 v29, v29
    v_exp_f32 v30, v30
    s_waitcnt lgkmcnt(2)
    v_mfma_f32_32x32x16_bf16 v[8:23], v[56:59], v[4:7], 0
    ds_read_b128 v[60:63], v83 offset:38912
    v_exp_f32 v31, v31
    v_exp_f32 v32, v32
    v_exp_f32 v33, v33
    v_exp_f32 v34, v34
    v_exp_f32 v35, v35
    s_waitcnt lgkmcnt(2)
    v_smfmac_f32_32x32x32_bf16 v[40:55], v[72:75], v[24:31], v80
    s_mov_b64 exec, s[48:49]
    ds_read_b128 v[64:67], v84 offset:36864
    ds_read_b128 v[68:71], v84 offset:37376
    s_mov_b64 exec, -1
    v_exp_f32 v36, v36
    v_exp_f32 v37, v37
    v_exp_f32 v38, v38
    v_exp_f32 v39, v39
    v_exp_f32 v8, v8
    v_exp_f32 v9, v9
    s_waitcnt lgkmcnt(3)
    v_smfmac_f32_32x32x32_bf16 v[40:55], v[76:79], v[32:39], v80
    buffer_load_dwordx4 v2, s[12:15], s50 offen offset:1024 lds
    v_exp_f32 v10, v10
    v_exp_f32 v11, v11
    v_exp_f32 v12, v12
    v_exp_f32 v13, v13
    v_exp_f32 v14, v14
    s_waitcnt lgkmcnt(2)
    v_mfma_f32_32x32x16_bf16 v[24:39], v[60:63], v[4:7], 0
    ds_read_b128 v[56:59], v83 offset:40960
    v_exp_f32 v15, v15
    v_exp_f32 v16, v16
    v_exp_f32 v17, v17
    v_exp_f32 v18, v18
    v_exp_f32 v19, v19
    s_waitcnt lgkmcnt(2)
    v_smfmac_f32_32x32x32_bf16 v[40:55], v[64:67], v[8:15], v80
    s_mov_b64 exec, s[48:49]
    ds_read_b128 v[72:75], v84 offset:38912
    ds_read_b128 v[76:79], v84 offset:39424
    s_mov_b64 exec, -1
    buffer_load_dwordx4 v[228:231], v85, s[12:15], s52 offen offset:2048
    v_exp_f32 v20, v20
    v_exp_f32 v21, v21
    v_exp_f32 v22, v22
    v_exp_f32 v23, v23
    v_exp_f32 v24, v24
    v_exp_f32 v25, v25
    s_waitcnt lgkmcnt(3)
    v_smfmac_f32_32x32x32_bf16 v[40:55], v[68:71], v[16:23], v80
    v_exp_f32 v26, v26
    v_exp_f32 v27, v27
    v_exp_f32 v28, v28
    v_exp_f32 v29, v29
    v_exp_f32 v30, v30
    s_waitcnt lgkmcnt(2)
    v_mfma_f32_32x32x16_bf16 v[8:23], v[56:59], v[4:7], 0
    ds_read_b128 v[60:63], v83 offset:43008
    v_exp_f32 v31, v31
    v_exp_f32 v32, v32
    v_exp_f32 v33, v33
    v_exp_f32 v34, v34
    v_exp_f32 v35, v35
    s_waitcnt lgkmcnt(2)
    v_smfmac_f32_32x32x32_bf16 v[40:55], v[72:75], v[24:31], v80
    s_mov_b64 exec, s[48:49]
    ds_read_b128 v[64:67], v84 offset:40960
    ds_read_b128 v[68:71], v84 offset:41472
    s_mov_b64 exec, -1
    v_exp_f32 v36, v36
    v_exp_f32 v37, v37
    v_exp_f32 v38, v38
    v_exp_f32 v39, v39
    v_exp_f32 v8, v8
    v_exp_f32 v9, v9
    s_waitcnt lgkmcnt(3)
    v_smfmac_f32_32x32x32_bf16 v[40:55], v[76:79], v[32:39], v80
    buffer_load_dwordx4 v2, s[12:15], s50 offen offset:2048 lds
    v_exp_f32 v10, v10
    v_exp_f32 v11, v11
    v_exp_f32 v12, v12
    v_exp_f32 v13, v13
    v_exp_f32 v14, v14
    s_waitcnt lgkmcnt(2)
    v_mfma_f32_32x32x16_bf16 v[24:39], v[60:63], v[4:7], 0
    ds_read_b128 v[56:59], v83 offset:45056
    v_exp_f32 v15, v15
    v_exp_f32 v16, v16
    v_exp_f32 v17, v17
    v_exp_f32 v18, v18
    v_exp_f32 v19, v19
    s_waitcnt lgkmcnt(2)
    v_smfmac_f32_32x32x32_bf16 v[40:55], v[64:67], v[8:15], v80
    s_mov_b64 exec, s[48:49]
    ds_read_b128 v[72:75], v84 offset:43008
    ds_read_b128 v[76:79], v84 offset:43520
    s_mov_b64 exec, -1
    buffer_load_dwordx4 v[232:235], v86, s[12:15], s52 offen offset:2048
    s_add_u32 s52, s52, 4096
    v_exp_f32 v20, v20
    v_exp_f32 v21, v21
    v_exp_f32 v22, v22
    v_exp_f32 v23, v23
    v_exp_f32 v24, v24
    v_exp_f32 v25, v25
    s_waitcnt lgkmcnt(3)
    v_smfmac_f32_32x32x32_bf16 v[40:55], v[68:71], v[16:23], v80
    v_exp_f32 v26, v26
    v_exp_f32 v27, v27
    v_exp_f32 v28, v28
    v_exp_f32 v29, v29
    v_exp_f32 v30, v30
    s_waitcnt lgkmcnt(2)
    v_mfma_f32_32x32x16_bf16 v[8:23], v[56:59], v[4:7], 0
    ds_read_b128 v[60:63], v83 offset:47104
    v_exp_f32 v31, v31
    v_exp_f32 v32, v32
    v_exp_f32 v33, v33
    v_exp_f32 v34, v34
    v_exp_f32 v35, v35
    s_waitcnt lgkmcnt(2)
    v_smfmac_f32_32x32x32_bf16 v[40:55], v[72:75], v[24:31], v80
    s_mov_b64 exec, s[48:49]
    ds_read_b128 v[64:67], v84 offset:45056
    ds_read_b128 v[68:71], v84 offset:45568
    s_mov_b64 exec, -1
    v_exp_f32 v36, v36
    v_exp_f32 v37, v37
    v_exp_f32 v38, v38
    v_exp_f32 v39, v39
    v_exp_f32 v8, v8
    v_exp_f32 v9, v9
    s_waitcnt lgkmcnt(3)
    v_smfmac_f32_32x32x32_bf16 v[40:55], v[76:79], v[32:39], v80
    buffer_load_dwordx4 v2, s[12:15], s50 offen offset:3072 lds
    v_exp_f32 v10, v10
    v_exp_f32 v11, v11
    v_exp_f32 v12, v12
    v_exp_f32 v13, v13
    v_exp_f32 v14, v14
    s_waitcnt lgkmcnt(2)
    v_mfma_f32_32x32x16_bf16 v[24:39], v[60:63], v[4:7], 0
    ds_read_b128 v[56:59], v83 offset:49152
    v_exp_f32 v15, v15
    v_exp_f32 v16, v16
    v_exp_f32 v17, v17
    v_exp_f32 v18, v18
    v_exp_f32 v19, v19
    s_waitcnt lgkmcnt(2)
    v_smfmac_f32_32x32x32_bf16 v[40:55], v[64:67], v[8:15], v80
    s_mov_b64 exec, s[48:49]
    ds_read_b128 v[72:75], v84 offset:47104
    ds_read_b128 v[76:79], v84 offset:47616
    s_mov_b64 exec, -1
    v_exp_f32 v20, v20
    v_exp_f32 v21, v21
    v_exp_f32 v22, v22
    v_exp_f32 v23, v23
    v_exp_f32 v24, v24
    v_exp_f32 v25, v25
    s_waitcnt lgkmcnt(3)
    v_smfmac_f32_32x32x32_bf16 v[40:55], v[68:71], v[16:23], v80
    buffer_load_dwordx4 v[236:239], v85, s[12:15], s52 offen offset:0
    v_exp_f32 v26, v26
    v_exp_f32 v27, v27
    v_exp_f32 v28, v28
    v_exp_f32 v29, v29
    v_exp_f32 v30, v30
    s_waitcnt lgkmcnt(2)
    v_mfma_f32_32x32x16_bf16 v[8:23], v[56:59], v[4:7], 0
    ds_read_b128 v[60:63], v83 offset:51200
    v_exp_f32 v31, v31
    v_exp_f32 v32, v32
    v_exp_f32 v33, v33
    v_exp_f32 v34, v34
    v_exp_f32 v35, v35
    s_waitcnt lgkmcnt(2)
    v_smfmac_f32_32x32x32_bf16 v[40:55], v[72:75], v[24:31], v80
    s_mov_b64 exec, s[48:49]
    ds_read_b128 v[64:67], v84 offset:49152
    ds_read_b128 v[68:71], v84 offset:49664
    s_mov_b64 exec, -1
    v_exp_f32 v36, v36
    v_exp_f32 v37, v37
    v_exp_f32 v38, v38
    v_exp_f32 v39, v39
    v_exp_f32 v8, v8
    v_exp_f32 v9, v9
    s_waitcnt lgkmcnt(3)
    v_smfmac_f32_32x32x32_bf16 v[40:55], v[76:79], v[32:39], v80
    s_add_u32 m0, s54, 53248
    s_add_u32 s50, s53, 53248
    buffer_load_dwordx4 v2, s[12:15], s50 offen offset:0 lds
    buffer_load_dwordx4 v[244:247], v252, s[4:7], s62 offen
    v_exp_f32 v10, v10
    v_exp_f32 v11, v11
    v_exp_f32 v12, v12
    v_exp_f32 v13, v13
    v_exp_f32 v14, v14
    s_waitcnt lgkmcnt(2)
    v_mfma_f32_32x32x16_bf16 v[24:39], v[60:63], v[4:7], 0
    ds_read_b128 v[56:59], v83 offset:53248
    v_exp_f32 v15, v15
    v_exp_f32 v16, v16
    v_exp_f32 v17, v17
    v_exp_f32 v18, v18
    v_exp_f32 v19, v19
    s_waitcnt lgkmcnt(2)
    v_smfmac_f32_32x32x32_bf16 v[40:55], v[64:67], v[8:15], v80
    s_mov_b64 exec, s[48:49]
    ds_read_b128 v[72:75], v84 offset:51200
    ds_read_b128 v[76:79], v84 offset:51712
    s_mov_b64 exec, -1
    v_exp_f32 v20, v20
    v_exp_f32 v21, v21
    v_exp_f32 v22, v22
    v_exp_f32 v23, v23
    v_exp_f32 v24, v24
    v_exp_f32 v25, v25
    s_waitcnt lgkmcnt(3)
    v_smfmac_f32_32x32x32_bf16 v[40:55], v[68:71], v[16:23], v80
    v_exp_f32 v26, v26
    v_exp_f32 v27, v27
    v_exp_f32 v28, v28
    v_exp_f32 v29, v29
    v_exp_f32 v30, v30
    s_waitcnt lgkmcnt(2)
    v_mfma_f32_32x32x16_bf16 v[8:23], v[56:59], v[4:7], 0
    ds_read_b128 v[60:63], v83 offset:55296
    v_exp_f32 v31, v31
    v_exp_f32 v32, v32
    v_exp_f32 v33, v33
    v_exp_f32 v34, v34
    v_exp_f32 v35, v35
    s_waitcnt lgkmcnt(2)
    v_smfmac_f32_32x32x32_bf16 v[40:55], v[72:75], v[24:31], v80
    s_mov_b64 exec, s[48:49]
    ds_read_b128 v[64:67], v84 offset:53248
    ds_read_b128 v[68:71], v84 offset:53760
    s_mov_b64 exec, -1
    buffer_load_dwordx4 v[240:243], v86, s[12:15], s52 offen offset:0
    v_exp_f32 v36, v36
    v_exp_f32 v37, v37
    v_exp_f32 v38, v38
    v_exp_f32 v39, v39
    v_exp_f32 v8, v8
    v_exp_f32 v9, v9
    s_waitcnt lgkmcnt(3)
    v_smfmac_f32_32x32x32_bf16 v[40:55], v[76:79], v[32:39], v80
    buffer_load_dwordx4 v2, s[12:15], s50 offen offset:1024 lds
    buffer_load_dword v89, v91, s[12:15], 0 offen sc1
    v_exp_f32 v10, v10
    v_exp_f32 v11, v11
    v_exp_f32 v12, v12
    v_exp_f32 v13, v13
    v_exp_f32 v14, v14
    s_waitcnt lgkmcnt(2)
    v_mfma_f32_32x32x16_bf16 v[24:39], v[60:63], v[4:7], 0
    ds_read_b128 v[56:59], v83 offset:57344
    v_exp_f32 v15, v15
    v_exp_f32 v16, v16
    v_exp_f32 v17, v17
    v_exp_f32 v18, v18
    v_exp_f32 v19, v19
    s_waitcnt lgkmcnt(2)
    v_smfmac_f32_32x32x32_bf16 v[40:55], v[64:67], v[8:15], v80
    s_mov_b64 exec, s[48:49]
    ds_read_b128 v[72:75], v84 offset:55296
    ds_read_b128 v[76:79], v84 offset:55808
    s_mov_b64 exec, -1
    v_exp_f32 v20, v20
    v_exp_f32 v21, v21
    v_exp_f32 v22, v22
    v_exp_f32 v23, v23
    v_exp_f32 v24, v24
    v_exp_f32 v25, v25
    s_waitcnt lgkmcnt(3)
    v_smfmac_f32_32x32x32_bf16 v[40:55], v[68:71], v[16:23], v80
    v_exp_f32 v26, v26
    v_exp_f32 v27, v27
    v_exp_f32 v28, v28
    v_exp_f32 v29, v29
    v_exp_f32 v30, v30
    s_waitcnt lgkmcnt(2)
    v_mfma_f32_32x32x16_bf16 v[8:23], v[56:59], v[4:7], 0
    ds_read_b128 v[60:63], v83 offset:59392
    v_exp_f32 v31, v31
    v_exp_f32 v32, v32
    v_exp_f32 v33, v33
    v_exp_f32 v34, v34
    v_exp_f32 v35, v35
    s_waitcnt lgkmcnt(2)
    v_smfmac_f32_32x32x32_bf16 v[40:55], v[72:75], v[24:31], v80
    s_mov_b64 exec, s[48:49]
    ds_read_b128 v[64:67], v84 offset:57344
    ds_read_b128 v[68:71], v84 offset:57856
    s_mov_b64 exec, -1
    v_exp_f32 v36, v36
    v_exp_f32 v37, v37
    v_exp_f32 v38, v38
    v_exp_f32 v39, v39
    v_exp_f32 v8, v8
    v_exp_f32 v9, v9
    s_waitcnt lgkmcnt(3)
    v_smfmac_f32_32x32x32_bf16 v[40:55], v[76:79], v[32:39], v80
    v_exp_f32 v10, v10
    v_exp_f32 v11, v11
    v_exp_f32 v12, v12
    v_exp_f32 v13, v13
    v_exp_f32 v14, v14
    s_waitcnt lgkmcnt(2)
    v_mfma_f32_32x32x16_bf16 v[24:39], v[60:63], v[4:7], 0
    ds_read_b128 v[56:59], v83 offset:61440
    v_exp_f32 v15, v15
    v_exp_f32 v16, v16
    v_exp_f32 v17, v17
    v_exp_f32 v18, v18
    v_exp_f32 v19, v19
    s_waitcnt lgkmcnt(2)
    v_smfmac_f32_32x32x32_bf16 v[40:55], v[64:67], v[8:15], v80
    s_mov_b64 exec, s[48:49]
    ds_read_b128 v[72:75], v84 offset:59392
    ds_read_b128 v[76:79], v84 offset:59904
    s_mov_b64 exec, -1
    v_exp_f32 v20, v20
    v_exp_f32 v21, v21
    v_exp_f32 v22, v22
    v_exp_f32 v23, v23
    v_exp_f32 v24, v24
    v_exp_f32 v25, v25
    s_waitcnt lgkmcnt(3)
    v_smfmac_f32_32x32x32_bf16 v[40:55], v[68:71], v[16:23], v80
    v_exp_f32 v26, v26
    v_exp_f32 v27, v27
    v_exp_f32 v28, v28
    v_exp_f32 v29, v29
    v_exp_f32 v30, v30
    s_waitcnt lgkmcnt(2)
    v_mfma_f32_32x32x16_bf16 v[8:23], v[56:59], v[4:7], 0
    ds_read_b128 v[60:63], v83 offset:63488
    v_exp_f32 v31, v31
    v_exp_f32 v32, v32
    v_exp_f32 v33, v33
    v_exp_f32 v34, v34
    v_exp_f32 v35, v35
    s_waitcnt lgkmcnt(2)
    v_smfmac_f32_32x32x32_bf16 v[40:55], v[72:75], v[24:31], v80
    s_mov_b64 exec, s[48:49]
    ds_read_b128 v[64:67], v84 offset:61440
    ds_read_b128 v[68:71], v84 offset:61952
    s_mov_b64 exec, -1
    v_exp_f32 v36, v36
    v_exp_f32 v37, v37
    v_exp_f32 v38, v38
    v_exp_f32 v39, v39
    v_exp_f32 v8, v8
    v_exp_f32 v9, v9
    s_waitcnt lgkmcnt(3)
    v_smfmac_f32_32x32x32_bf16 v[40:55], v[76:79], v[32:39], v80
    v_exp_f32 v10, v10
    v_exp_f32 v11, v11
    v_exp_f32 v12, v12
    v_exp_f32 v13, v13
    v_exp_f32 v14, v14
    s_waitcnt lgkmcnt(2)
    v_mfma_f32_32x32x16_bf16 v[24:39], v[60:63], v[4:7], 0
    v_exp_f32 v15, v15
    v_exp_f32 v16, v16
    v_exp_f32 v17, v17
    v_exp_f32 v18, v18
    v_exp_f32 v19, v19
    s_waitcnt lgkmcnt(1)
    v_smfmac_f32_32x32x32_bf16 v[40:55], v[64:67], v[8:15], v80
    s_mov_b64 exec, s[48:49]
    ds_read_b128 v[72:75], v84 offset:63488
    ds_read_b128 v[76:79], v84 offset:64000
    s_mov_b64 exec, -1
    v_exp_f32 v20, v20
    v_exp_f32 v21, v21
    v_exp_f32 v22, v22
    v_exp_f32 v23, v23
    v_exp_f32 v24, v24
    v_exp_f32 v25, v25
    s_waitcnt lgkmcnt(2)
    v_smfmac_f32_32x32x32_bf16 v[40:55], v[68:71], v[16:23], v80
    v_exp_f32 v26, v26
    v_exp_f32 v27, v27
    v_exp_f32 v28, v28
    v_exp_f32 v29, v29
    v_exp_f32 v30, v30
    v_exp_f32 v31, v31
    v_exp_f32 v32, v32
    v_exp_f32 v33, v33
    v_exp_f32 v34, v34
    v_exp_f32 v35, v35
    s_waitcnt lgkmcnt(1)
    v_smfmac_f32_32x32x32_bf16 v[40:55], v[72:75], v[24:31], v80
    v_exp_f32 v36, v36
    v_exp_f32 v37, v37
    v_exp_f32 v38, v38
    v_exp_f32 v39, v39
    s_waitcnt lgkmcnt(0)
    s_nop 0
    v_smfmac_f32_32x32x32_bf16 v[40:55], v[76:79], v[32:39], v80
    s_setprio 0
    s_waitcnt vmcnt(0) lgkmcnt(0)
    s_mov_b32 s41, 131072
    s_branch L_cchk_45
L_cpoll_43:
    buffer_load_dword v89, v91, s[12:15], 0 offen sc1
    s_waitcnt vmcnt(0)
L_cchk_45:
    v_xor_b32 v88, s40, v89
    v_lshlrev_b32 v87, 4, v88
    v_cmp_ne_u32 vcc, 0, v87
    s_cbranch_vccz L_cdone_44
    s_sub_u32 s41, s41, 1
    s_cbranch_scc0 L_cpoll_43
L_cdone_44:
    v_cmp_ne_u32 vcc, 0, v88
    s_cmp_eq_u32 vcc_lo, 0
    s_cselect_b32 s39, 1, 0
    s_nop 15
    s_nop 3
L_attn_done:
    v_mov_b32 v3, 0
    v_fma_f32 v3, v40, 0, v3
    v_fma_f32 v3, v41, 0, v3
    v_fma_f32 v3, v42, 0, v3
    v_fma_f32 v3, v43, 0, v3
    v_fma_f32 v3, v44, 0, v3
    v_fma_f32 v3, v45, 0, v3
    v_fma_f32 v3, v46, 0, v3
    v_fma_f32 v3, v47, 0, v3
    v_cmp_u_f32 vcc, v3, v3
    v_mov_b32 v3, 0x1f800000
    v_cmp_nle_f32 s[42:43], v3, v48
    v_mov_b32 v3, 0x5f800000
    v_cmp_nge_f32 s[44:45], v3, v48
    s_or_b64 vcc, vcc, s[42:43]
    s_or_b64 vcc, vcc, s[44:45]
    s_cbranch_scc1 L_fallback
L_attn_fin:
    v_rcp_f32 v3, v48
    s_lshl_b32 s42, s59, 5
    s_add_u32 s42, s42, s58
    s_lshl_b32 s42, s42, 10
    s_add_u32 s42, s42, 8388608
    v_mul_f32 v40, v40, v3
    v_mul_f32 v41, v41, v3
    v_mul_f32 v42, v42, v3
    v_mul_f32 v43, v43, v3
    v_mul_f32 v44, v44, v3
    v_mul_f32 v45, v45, v3
    v_mul_f32 v46, v46, v3
    v_mul_f32 v47, v47, v3
    v_cvt_pk_bf16_f32 v56, v40, v41
    v_cvt_pk_bf16_f32 v57, v42, v43
    v_cvt_pk_bf16_f32 v58, v44, v45
    v_cvt_pk_bf16_f32 v59, v46, v47
    v_min_u32 v56, -2, v56
    v_min_u32 v57, -2, v57
    v_min_u32 v58, -2, v58
    v_min_u32 v59, -2, v59
    buffer_store_dwordx4 v[56:59], v2, s[12:15], s42 offen sc1
    s_lshr_b32 s46, s3, 1
    s_lshl_b32 s45, s60, 5
    s_lshl_b32 s44, s46, 3
    s_add_u32 s45, s45, s44
    s_lshl_b32 s45, s45, 10
    s_add_u32 s45, s45, 8388608
    s_add_u32 s47, s45, 4096
    v_add_u32 v254, 49152, v2
    s_mul_i32 s44, s3, 12288
    v_add_u32 v88, s44, v2
    v_lshrrev_b32 v3, 2, v1
    v_xor_b32 v3, v3, v1
    v_bfe_u32 v3, v3, 2, 1
    v_add_u32 v3, -1, v3
    v_and_b32 v84, 0x3f803f80, v3
    v_and_b32 v85, 0x3f803f80, v3
    v_and_b32 v86, 0x3f803f80, v3
    v_and_b32 v87, 0x3f803f80, v3
    v_add_u32 v91, 160512, v90
    s_barrier
    ds_read_b128 v[36:39], v88 offset:0
    ds_read_b128 v[40:43], v88 offset:1024
    ds_read_b128 v[44:47], v88 offset:2048
    ds_read_b128 v[48:51], v88 offset:3072
    ds_read_b128 v[52:55], v88 offset:4096
    ds_read_b128 v[56:59], v88 offset:5120
    s_waitcnt lgkmcnt(5)
    v_mfma_f32_16x16x32_bf16 v[60:63], v[84:87], v[36:39], 0
    s_waitcnt lgkmcnt(4)
    v_mfma_f32_16x16x32_bf16 v[64:67], v[84:87], v[40:43], 0
    s_waitcnt lgkmcnt(3)
    v_mfma_f32_16x16x32_bf16 v[68:71], v[84:87], v[44:47], 0
    s_waitcnt lgkmcnt(2)
    v_mfma_f32_16x16x32_bf16 v[60:63], v[84:87], v[48:51], v[60:63]
    s_waitcnt lgkmcnt(1)
    v_mfma_f32_16x16x32_bf16 v[64:67], v[84:87], v[52:55], v[64:67]
    s_waitcnt lgkmcnt(0)
    v_mfma_f32_16x16x32_bf16 v[68:71], v[84:87], v[56:59], v[68:71]
    ds_read_b128 v[36:39], v88 offset:6144
    ds_read_b128 v[40:43], v88 offset:7168
    ds_read_b128 v[44:47], v88 offset:8192
    ds_read_b128 v[48:51], v88 offset:9216
    ds_read_b128 v[52:55], v88 offset:10240
    ds_read_b128 v[56:59], v88 offset:11264
    s_waitcnt lgkmcnt(5)
    v_mfma_f32_16x16x32_bf16 v[60:63], v[84:87], v[36:39], v[60:63]
    s_waitcnt lgkmcnt(4)
    v_mfma_f32_16x16x32_bf16 v[64:67], v[84:87], v[40:43], v[64:67]
    s_waitcnt lgkmcnt(3)
    v_mfma_f32_16x16x32_bf16 v[68:71], v[84:87], v[44:47], v[68:71]
    s_waitcnt lgkmcnt(2)
    v_mfma_f32_16x16x32_bf16 v[60:63], v[84:87], v[48:51], v[60:63]
    s_waitcnt lgkmcnt(1)
    v_mfma_f32_16x16x32_bf16 v[64:67], v[84:87], v[52:55], v[64:67]
    s_waitcnt lgkmcnt(0)
    v_mfma_f32_16x16x32_bf16 v[68:71], v[84:87], v[56:59], v[68:71]
    s_mov_b64 exec, 0xffffffff
    s_nop 2
    ds_add_f32 v91, v60 offset:0
    s_nop 0
    ds_add_f32 v91, v64 offset:128
    s_nop 0
    ds_add_f32 v91, v68 offset:256
    s_mov_b64 exec, -1
    s_mov_b32 s41, 131072
L_spoll_46:
    buffer_load_dwordx4 v[4:7], v2, s[12:15], s45 offen offset:0 sc1
    buffer_load_dwordx4 v[8:11], v2, s[12:15], s45 offen offset:1024 sc1
    buffer_load_dwordx4 v[12:15], v2, s[12:15], s45 offen offset:2048 sc1
    buffer_load_dwordx4 v[16:19], v2, s[12:15], s45 offen offset:3072 sc1
    buffer_load_dwordx4 v[20:23], v2, s[12:15], s47 offen offset:0 sc1
    buffer_load_dwordx4 v[24:27], v2, s[12:15], s47 offen offset:1024 sc1
    buffer_load_dwordx4 v[28:31], v2, s[12:15], s47 offen offset:2048 sc1
    buffer_load_dwordx4 v[32:35], v2, s[12:15], s47 offen offset:3072 sc1
    s_waitcnt vmcnt(0)
    v_max3_u32 v3, v4, v5, v6
    v_max_u32 v3, v3, v7
    v_max3_u32 v3, v3, v8, v9
    v_max3_u32 v3, v3, v10, v11
    v_max3_u32 v3, v3, v12, v13
    v_max3_u32 v3, v3, v14, v15
    v_max3_u32 v3, v3, v16, v17
    v_max3_u32 v3, v3, v18, v19
    v_max3_u32 v3, v3, v20, v21
    v_max3_u32 v3, v3, v22, v23
    v_max3_u32 v3, v3, v24, v25
    v_max3_u32 v3, v3, v26, v27
    v_max3_u32 v3, v3, v28, v29
    v_max3_u32 v3, v3, v30, v31
    v_max3_u32 v3, v3, v32, v33
    v_max3_u32 v3, v3, v34, v35
    v_cmp_eq_u32 vcc, -1, v3
    s_cbranch_vccz L_sdone_47
    s_sub_u32 s41, s41, 1
    s_cbranch_scc0 L_spoll_46
L_sdone_47:
    s_xor_b32 s44, s3, 2
    s_mul_i32 s44, s44, 6144
    s_add_u32 s44, s44, 98304
    v_add_u32 v85, s44, v2
    s_xor_b32 s44, s3, 4
    s_mul_i32 s44, s44, 6144
    s_add_u32 s44, s44, 100352
    v_add_u32 v86, s44, v2
    s_xor_b32 s44, s3, 6
    s_mul_i32 s44, s44, 6144
    s_add_u32 s44, s44, 102400
    v_add_u32 v87, s44, v2
    s_mul_i32 s44, s3, 6144
    s_add_u32 s44, s44, 98304
    v_add_u32 v84, s44, v2
    v_mfma_f32_32x32x16_bf16 v[52:67], v[96:99], v[4:7], 0
    v_mfma_f32_32x32x16_bf16 v[52:67], v[104:107], v[8:11], v[52:67]
    v_mfma_f32_32x32x16_bf16 v[52:67], v[112:115], v[12:15], v[52:67]
    v_mfma_f32_32x32x16_bf16 v[52:67], v[120:123], v[16:19], v[52:67]
    v_mfma_f32_32x32x16_bf16 v[52:67], v[128:131], v[20:23], v[52:67]
    v_mfma_f32_32x32x16_bf16 v[52:67], v[136:139], v[24:27], v[52:67]
    v_mfma_f32_32x32x16_bf16 v[52:67], v[144:147], v[28:31], v[52:67]
    v_mfma_f32_32x32x16_bf16 v[52:67], v[152:155], v[32:35], v[52:67]
    v_mfma_f32_32x32x16_bf16 v[36:51], v[92:95], v[4:7], 0
    v_mfma_f32_32x32x16_bf16 v[36:51], v[100:103], v[8:11], v[36:51]
    v_mfma_f32_32x32x16_bf16 v[36:51], v[108:111], v[12:15], v[36:51]
    s_nop 8
    ds_write_b128 v86, v[52:55] offset:0
    v_mfma_f32_32x32x16_bf16 v[36:51], v[116:119], v[16:19], v[36:51]
    ds_write_b128 v86, v[56:59] offset:1024
    v_mfma_f32_32x32x16_bf16 v[36:51], v[124:127], v[20:23], v[36:51]
    ds_write_b128 v87, v[60:63] offset:0
    v_mfma_f32_32x32x16_bf16 v[36:51], v[132:135], v[24:27], v[36:51]
    ds_write_b128 v87, v[64:67] offset:1024
    v_mfma_f32_32x32x16_bf16 v[36:51], v[140:143], v[28:31], v[36:51]
    v_mfma_f32_32x32x16_bf16 v[36:51], v[148:151], v[32:35], v[36:51]
    s_nop 11
    ds_write_b128 v85, v[44:47] offset:0
    ds_write_b128 v85, v[48:51] offset:1024
    v_lshlrev_b32 v4, 16, v244
    v_and_b32 v5, 0xffff0000, v244
    v_lshlrev_b32 v6, 16, v245
    v_and_b32 v7, 0xffff0000, v245
    v_lshlrev_b32 v8, 16, v246
    v_and_b32 v9, 0xffff0000, v246
    v_lshlrev_b32 v10, 16, v247
    v_and_b32 v11, 0xffff0000, v247
    v_add_f32 v36, v36, v4
    v_add_f32 v37, v37, v5
    v_add_f32 v38, v38, v6
    v_add_f32 v39, v39, v7
    v_add_f32 v40, v40, v8
    v_add_f32 v41, v41, v9
    v_add_f32 v42, v42, v10
    v_add_f32 v43, v43, v11
    s_waitcnt lgkmcnt(0)
    s_barrier
    ds_read_b128 v[44:47], v84 offset:0
    ds_read_b128 v[48:51], v84 offset:1024
    ds_read_b128 v[52:55], v84 offset:2048
    ds_read_b128 v[56:59], v84 offset:3072
    ds_read_b128 v[60:63], v84 offset:4096
    ds_read_b128 v[64:67], v84 offset:5120
    s_lshl_b32 s44, s60, 3
    s_add_u32 s44, s44, s61
    s_lshl_b32 s44, s44, 2
    s_lshr_b32 s45, s3, 1
    s_add_u32 s44, s44, s45
    s_lshl_b32 s44, s44, 10
    s_add_u32 s44, s44, 10485760
    s_waitcnt lgkmcnt(5)
    v_add_f32 v36, v36, v44
    v_add_f32 v37, v37, v45
    v_add_f32 v38, v38, v46
    v_add_f32 v39, v39, v47
    s_waitcnt lgkmcnt(4)
    v_add_f32 v40, v40, v48
    v_add_f32 v41, v41, v49
    v_add_f32 v42, v42, v50
    v_add_f32 v43, v43, v51
    s_waitcnt lgkmcnt(3)
    v_add_f32 v36, v36, v52
    v_add_f32 v37, v37, v53
    v_add_f32 v38, v38, v54
    v_add_f32 v39, v39, v55
    s_waitcnt lgkmcnt(2)
    v_add_f32 v40, v40, v56
    v_add_f32 v41, v41, v57
    v_add_f32 v42, v42, v58
    v_add_f32 v43, v43, v59
    s_waitcnt lgkmcnt(1)
    v_add_f32 v36, v36, v60
    v_add_f32 v37, v37, v61
    v_add_f32 v38, v38, v62
    v_add_f32 v39, v39, v63
    s_waitcnt lgkmcnt(0)
    v_add_f32 v40, v40, v64
    v_add_f32 v41, v41, v65
    v_add_f32 v42, v42, v66
    v_add_f32 v43, v43, v67
    v_cvt_pk_bf16_f32 v248, v36, v37
    v_cvt_pk_bf16_f32 v249, v38, v39
    v_cvt_pk_bf16_f32 v250, v40, v41
    v_cvt_pk_bf16_f32 v251, v42, v43
    v_min_u32 v248, -2, v248
    v_min_u32 v249, -2, v249
    v_min_u32 v250, -2, v250
    v_min_u32 v251, -2, v251
    s_cmp_lg_u32 s39, 0
    s_cbranch_scc1 L_fast_49
    buffer_store_dwordx4 v[248:251], v2, s[12:15], s44 offen sc1
    s_branch L_fdone_50
L_fast_49:
    buffer_store_dwordx4 v[248:251], v2, s[12:15], s44 offen
L_fdone_50:
    v_add_f32 v4, v36, v37
    v_mul_f32 v5, v36, v36
    v_fmac_f32 v5, v37, v37
    v_add_f32 v4, v4, v38
    v_fmac_f32 v5, v38, v38
    v_add_f32 v4, v4, v39
    v_fmac_f32 v5, v39, v39
    v_add_f32 v4, v4, v40
    v_fmac_f32 v5, v40, v40
    v_add_f32 v4, v4, v41
    v_fmac_f32 v5, v41, v41
    v_add_f32 v4, v4, v42
    v_fmac_f32 v5, v42, v42
    v_add_f32 v4, v4, v43
    v_fmac_f32 v5, v43, v43
    v_mov_b32 v6, v4
    v_mov_b32 v7, v5
    s_nop 0
    v_permlane32_swap_b32 v6, v4
    v_permlane32_swap_b32 v7, v5
    v_add_f32 v4, v4, v6
    v_add_f32 v5, v5, v7
    s_and_b32 s44, s3, 1
    s_lshl_b32 s44, s44, 8
    s_add_u32 s44, s44, 161024
    v_lshl_add_u32 v6, v90, 1, s44
    s_mov_b64 exec, 0xffffffff
    ds_add_f32 v6, v4
    ds_add_f32 v6, v5 offset:4
    s_mov_b64 exec, -1
    v_mov_b32 v253, v91
    s_waitcnt lgkmcnt(0)
    s_barrier
    s_cmp_ge_u32 s3, 2
    s_cbranch_scc1 L_nost_51
    ds_read_b64 v[4:5], v6
    s_lshl_b32 s44, s60, 3
    s_add_u32 s44, s44, s61
    s_lshl_b32 s44, s44, 9
    s_add_u32 s44, s44, 131072
    v_mov_b32 v13, s36
    v_mov_b32 v15, s36
    v_lshlrev_b32 v7, 2, v90
    s_waitcnt lgkmcnt(0)
    v_mov_b32 v12, v4
    v_mov_b32 v14, v5
    s_mov_b64 exec, 0xffffffff
    s_cmp_lg_u32 s39, 0
    s_cbranch_scc1 L_fast_52
    buffer_store_dwordx4 v[12:15], v7, s[12:15], s44 offen sc1
    s_branch L_fdone_53
L_fast_52:
    buffer_store_dwordx4 v[12:15], v7, s[12:15], s44 offen
L_fdone_53:
    s_mov_b64 exec, -1
L_nost_51:
    s_cmp_lt_u32 s38, 29
    s_cbranch_scc1 L_dgo_54
    v_mov_b32 v3, 161548
    v_mov_b32 v246, 1
    s_mov_b64 exec, 1
    ds_add_u32 v3, v246
    s_mov_b64 exec, -1
    s_branch L_djoin
L_dgo_54:
    s_lshl_b32 s46, s37, 2
    s_and_b32 s44, s3, 3
    s_add_u32 s46, s46, s44
    s_lshl_b32 s46, s46, 1
    s_lshr_b32 s44, s3, 2
    s_add_u32 s46, s46, s44
    s_lshl_b32 s44, s46, 15
    s_add_u32 s44, s44, 10485760
    s_lshl_b32 s47, s46, 12
    s_add_u32 s47, s47, 131072
    v_lshrrev_b32 v3, 5, v1
    v_lshlrev_b32 v247, 11, v3
    v_lshl_add_u32 v247, v90, 2, v247
    v_lshlrev_b32 v255, 12, v1
    v_add_u32 v255, 4092, v255
    s_mov_b32 s101, 16
    s_cmp_ge_u32 s3, 4
    s_cbranch_scc1 L_dyoung_55
    s_setprio 2
L_dyoung_55:
L_dredo:
    v_mov_b32 v3, 0
    ds_read_b128 v[52:55], v2 offset:0
    ds_read_b128 v[56:59], v2 offset:1024
    ds_read_b128 v[60:63], v2 offset:2048
    ds_read_b128 v[64:67], v2 offset:3072
    ds_read_b128 v[68:71], v2 offset:4096
    ds_read_b128 v[72:75], v2 offset:5120
    s_mov_b32 s41, 131072
L_spoll_56:
    s_mov_b32 s45, s44
    s_mov_b64 exec, 0xff
    buffer_load_dword v3, v255, s[12:15], s44 offen sc1
    s_mov_b64 exec, -1
    buffer_load_dwordx4 v[76:79], v2, s[12:15], s45 offen offset:0 sc1
    buffer_load_dwordx4 v[80:83], v2, s[12:15], s45 offen offset:1024 sc1
    buffer_load_dwordx4 v[84:87], v2, s[12:15], s45 offen offset:2048 sc1
    s_waitcnt vmcnt(0)
    v_cmp_eq_u32 vcc, -1, v3
    s_cbranch_vccz L_sdone_57
    s_sub_u32 s41, s41, 1
    s_cbranch_scc0 L_spoll_56
L_sdone_57:
    buffer_load_dwordx4 v[88:91], v2, s[12:15], s45 offen offset:3072 sc1
    s_add_u32 s45, s45, 4096
    buffer_load_dwordx4 v[92:95], v2, s[12:15], s45 offen offset:0 sc1
    buffer_load_dwordx4 v[96:99], v2, s[12:15], s45 offen offset:1024 sc1
    ds_read_b128 v[124:127], v2 offset:6144
    s_waitcnt lgkmcnt(6)
    v_mfma_f32_32x32x16_bf16 v[4:19], v[52:55], v[76:79], 0
    v_max3_u32 v246, v76, v77, v78
    v_max_u32 v246, v246, v79
    ds_read_b128 v[128:131], v2 offset:7168
    s_waitcnt lgkmcnt(6)
    v_mfma_f32_32x32x16_bf16 v[20:35], v[56:59], v[76:79], 0
    buffer_load_dwordx4 v[100:103], v2, s[12:15], s45 offen offset:2048 sc1
    ds_read_b128 v[132:135], v2 offset:8192
    s_waitcnt lgkmcnt(6)
    v_mfma_f32_32x32x16_bf16 v[36:51], v[60:63], v[76:79], 0
    buffer_load_dwordx4 v[104:107], v2, s[12:15], s45 offen offset:3072 sc1
    ds_read_b128 v[52:55], v2 offset:9216
    s_waitcnt lgkmcnt(6)
    v_mfma_f32_32x32x16_bf16 v[4:19], v[64:67], v[80:83], v[4:19]
    v_max3_u32 v246, v246, v80, v81
    v_max3_u32 v246, v246, v82, v83
    ds_read_b128 v[56:59], v2 offset:10240
    s_waitcnt lgkmcnt(6)
    v_mfma_f32_32x32x16_bf16 v[20:35], v[68:71], v[80:83], v[20:35]
    s_add_u32 s45, s45, 4096
    buffer_load_dwordx4 v[108:111], v2, s[12:15], s45 offen offset:0 sc1
    ds_read_b128 v[60:63], v2 offset:11264
    s_waitcnt lgkmcnt(6)
    v_mfma_f32_32x32x16_bf16 v[36:51], v[72:75], v[80:83], v[36:51]
    buffer_load_dwordx4 v[112:115], v2, s[12:15], s45 offen offset:1024 sc1
    ds_read_b128 v[64:67], v2 offset:12288
    s_waitcnt lgkmcnt(6)
    v_mfma_f32_32x32x16_bf16 v[4:19], v[124:127], v[84:87], v[4:19]
    v_max3_u32 v246, v246, v84, v85
    v_max3_u32 v246, v246, v86, v87
    ds_read_b128 v[68:71], v2 offset:13312
    s_waitcnt lgkmcnt(6)
    v_mfma_f32_32x32x16_bf16 v[20:35], v[128:131], v[84:87], v[20:35]
    buffer_load_dwordx4 v[116:119], v2, s[12:15], s45 offen offset:2048 sc1
    ds_read_b128 v[72:75], v2 offset:14336
    s_waitcnt lgkmcnt(6)
    v_mfma_f32_32x32x16_bf16 v[36:51], v[132:135], v[84:87], v[36:51]
    buffer_load_dwordx4 v[120:123], v2, s[12:15], s45 offen offset:3072 sc1
    ds_read_b128 v[124:127], v2 offset:15360
    s_waitcnt vmcnt(8) lgkmcnt(6)
    v_mfma_f32_32x32x16_bf16 v[4:19], v[52:55], v[88:91], v[4:19]
    v_max3_u32 v246, v246, v88, v89
    v_max3_u32 v246, v246, v90, v91
    ds_read_b128 v[128:131], v2 offset:16384
    s_waitcnt lgkmcnt(6)
    v_mfma_f32_32x32x16_bf16 v[20:35], v[56:59], v[88:91], v[20:35]
    s_add_u32 s45, s45, 4096
    buffer_load_dwordx4 v[76:79], v2, s[12:15], s45 offen offset:0 sc1
    ds_read_b128 v[132:135], v2 offset:17408
    s_waitcnt lgkmcnt(6)
    v_mfma_f32_32x32x16_bf16 v[36:51], v[60:63], v[88:91], v[36:51]
    buffer_load_dwordx4 v[80:83], v2, s[12:15], s45 offen offset:1024 sc1
    ds_read_b128 v[52:55], v2 offset:18432
    s_waitcnt vmcnt(9) lgkmcnt(6)
    v_mfma_f32_32x32x16_bf16 v[4:19], v[64:67], v[92:95], v[4:19]
    v_max3_u32 v246, v246, v92, v93
    v_max3_u32 v246, v246, v94, v95
    ds_read_b128 v[56:59], v2 offset:19456
    s_waitcnt lgkmcnt(6)
    v_mfma_f32_32x32x16_bf16 v[20:35], v[68:71], v[92:95], v[20:35]
    buffer_load_dwordx4 v[84:87], v2, s[12:15], s45 offen offset:2048 sc1
    ds_read_b128 v[60:63], v2 offset:20480
    s_waitcnt lgkmcnt(6)
    v_mfma_f32_32x32x16_bf16 v[36:51], v[72:75], v[92:95], v[36:51]
    buffer_load_dwordx4 v[88:91], v2, s[12:15], s45 offen offset:3072 sc1
    ds_read_b128 v[64:67], v2 offset:21504
    s_waitcnt vmcnt(10) lgkmcnt(6)
    v_mfma_f32_32x32x16_bf16 v[4:19], v[124:127], v[96:99], v[4:19]
    v_max3_u32 v246, v246, v96, v97
    v_max3_u32 v246, v246, v98, v99
    ds_read_b128 v[68:71], v2 offset:22528
    s_waitcnt lgkmcnt(6)
    v_mfma_f32_32x32x16_bf16 v[20:35], v[128:131], v[96:99], v[20:35]
    s_add_u32 s45, s45, 4096
    buffer_load_dwordx4 v[92:95], v2, s[12:15], s45 offen offset:0 sc1
    ds_read_b128 v[72:75], v2 offset:23552
    s_waitcnt lgkmcnt(6)
    v_mfma_f32_32x32x16_bf16 v[36:51], v[132:135], v[96:99], v[36:51]
    buffer_load_dwordx4 v[96:99], v2, s[12:15], s45 offen offset:1024 sc1
    ds_read_b128 v[124:127], v2 offset:24576
    s_waitcnt vmcnt(11) lgkmcnt(6)
    v_mfma_f32_32x32x16_bf16 v[4:19], v[52:55], v[100:103], v[4:19]
    v_max3_u32 v246, v246, v100, v101
    v_max3_u32 v246, v246, v102, v103
    ds_read_b128 v[128:131], v2 offset:25600
    s_waitcnt lgkmcnt(6)
    v_mfma_f32_32x32x16_bf16 v[20:35], v[56:59], v[100:103], v[20:35]
    ds_read_b128 v[132:135], v2 offset:26624
    s_waitcnt lgkmcnt(6)
    v_mfma_f32_32x32x16_bf16 v[36:51], v[60:63], v[100:103], v[36:51]
    buffer_load_dwordx4 v[100:103], v2, s[12:15], s45 offen offset:2048 sc1
    ds_read_b128 v[52:55], v2 offset:27648
    s_waitcnt vmcnt(11) lgkmcnt(6)
    v_mfma_f32_32x32x16_bf16 v[4:19], v[64:67], v[104:107], v[4:19]
    v_max3_u32 v246, v246, v104, v105
    v_max3_u32 v246, v246, v106, v107
    ds_read_b128 v[56:59], v2 offset:28672
    s_waitcnt lgkmcnt(6)
    v_mfma_f32_32x32x16_bf16 v[20:35], v[68:71], v[104:107], v[20:35]
    ds_read_b128 v[60:63], v2 offset:29696
    s_waitcnt lgkmcnt(6)
    v_mfma_f32_32x32x16_bf16 v[36:51], v[72:75], v[104:107], v[36:51]
    buffer_load_dwordx4 v[104:107], v2, s[12:15], s45 offen offset:3072 sc1
    ds_read_b128 v[64:67], v2 offset:30720
    s_waitcnt vmcnt(11) lgkmcnt(6)
    v_mfma_f32_32x32x16_bf16 v[4:19], v[124:127], v[108:111], v[4:19]
    v_max3_u32 v246, v246, v108, v109
    v_max3_u32 v246, v246, v110, v111
    ds_read_b128 v[68:71], v2 offset:31744
    s_waitcnt lgkmcnt(6)
    v_mfma_f32_32x32x16_bf16 v[20:35], v[128:131], v[108:111], v[20:35]
    ds_read_b128 v[72:75], v2 offset:32768
    s_waitcnt lgkmcnt(6)
    v_mfma_f32_32x32x16_bf16 v[36:51], v[132:135], v[108:111], v[36:51]
    s_add_u32 s45, s45, 4096
    buffer_load_dwordx4 v[108:111], v2, s[12:15], s45 offen offset:0 sc1
    buffer_load_dwordx4 v[136:139], v247, s[12:15], s47 offen offset:0 sc1
    buffer_load_dwordx4 v[140:143], v247, s[12:15], s47 offen offset:512 sc1
    buffer_load_dwordx4 v[144:147], v247, s[12:15], s47 offen offset:1024 sc1
    buffer_load_dwordx4 v[148:151], v247, s[12:15], s47 offen offset:1536 sc1
    ds_read_b128 v[124:127], v2 offset:33792
    s_waitcnt vmcnt(15) lgkmcnt(6)
    v_mfma_f32_32x32x16_bf16 v[4:19], v[52:55], v[112:115], v[4:19]
    v_max3_u32 v246, v246, v112, v113
    v_max3_u32 v246, v246, v114, v115
    ds_read_b128 v[128:131], v2 offset:34816
    s_waitcnt lgkmcnt(6)
    v_mfma_f32_32x32x16_bf16 v[20:35], v[56:59], v[112:115], v[20:35]
    ds_read_b128 v[132:135], v2 offset:35840
    s_waitcnt lgkmcnt(6)
    v_mfma_f32_32x32x16_bf16 v[36:51], v[60:63], v[112:115], v[36:51]
    buffer_load_dwordx4 v[112:115], v2, s[12:15], s45 offen offset:1024 sc1
    ds_read_b128 v[52:55], v2 offset:36864
    s_waitcnt vmcnt(15) lgkmcnt(6)
    v_mfma_f32_32x32x16_bf16 v[4:19], v[64:67], v[116:119], v[4:19]
    v_max3_u32 v246, v246, v116, v117
    v_max3_u32 v246, v246, v118, v119
    ds_read_b128 v[56:59], v2 offset:37888
    s_waitcnt lgkmcnt(6)
    v_mfma_f32_32x32x16_bf16 v[20:35], v[68:71], v[116:119], v[20:35]
    ds_read_b128 v[60:63], v2 offset:38912
    s_waitcnt lgkmcnt(6)
    v_mfma_f32_32x32x16_bf16 v[36:51], v[72:75], v[116:119], v[36:51]
    buffer_load_dwordx4 v[116:119], v2, s[12:15], s45 offen offset:2048 sc1
    ds_read_b128 v[64:67], v2 offset:39936
    s_waitcnt vmcnt(15) lgkmcnt(6)
    v_mfma_f32_32x32x16_bf16 v[4:19], v[124:127], v[120:123], v[4:19]
    v_max3_u32 v246, v246, v120, v121
    v_max3_u32 v246, v246, v122, v123
    ds_read_b128 v[68:71], v2 offset:40960
    s_waitcnt lgkmcnt(6)
    v_mfma_f32_32x32x16_bf16 v[20:35], v[128:131], v[120:123], v[20:35]
    ds_read_b128 v[72:75], v2 offset:41984
    s_waitcnt lgkmcnt(6)
    v_mfma_f32_32x32x16_bf16 v[36:51], v[132:135], v[120:123], v[36:51]
    buffer_load_dwordx4 v[120:123], v2, s[12:15], s45 offen offset:3072 sc1
    ds_read_b128 v[124:127], v2 offset:43008
    s_waitcnt vmcnt(15) lgkmcnt(6)
    v_mfma_f32_32x32x16_bf16 v[4:19], v[52:55], v[76:79], v[4:19]
    v_max3_u32 v246, v246, v76, v77
    v_max3_u32 v246, v246, v78, v79
    ds_read_b128 v[128:131], v2 offset:44032
    s_waitcnt lgkmcnt(6)
    v_mfma_f32_32x32x16_bf16 v[20:35], v[56:59], v[76:79], v[20:35]
    ds_read_b128 v[132:135], v2 offset:45056
    s_waitcnt lgkmcnt(6)
    v_mfma_f32_32x32x16_bf16 v[36:51], v[60:63], v[76:79], v[36:51]
    s_add_u32 s45, s45, 4096
    buffer_load_dwordx4 v[76:79], v2, s[12:15], s45 offen offset:0 sc1
    ds_read_b128 v[52:55], v2 offset:46080
    s_waitcnt vmcnt(15) lgkmcnt(6)
    v_mfma_f32_32x32x16_bf16 v[4:19], v[64:67], v[80:83], v[4:19]
    v_max3_u32 v246, v246, v80, v81
    v_max3_u32 v246, v246, v82, v83
    ds_read_b128 v[56:59], v2 offset:47104
    s_waitcnt lgkmcnt(6)
    v_mfma_f32_32x32x16_bf16 v[20:35], v[68:71], v[80:83], v[20:35]
    ds_read_b128 v[60:63], v2 offset:48128
    s_waitcnt lgkmcnt(6)
    v_mfma_f32_32x32x16_bf16 v[36:51], v[72:75], v[80:83], v[36:51]
    buffer_load_dwordx4 v[80:83], v2, s[12:15], s45 offen offset:1024 sc1
    ds_read_b128 v[64:67], v254 offset:0
    s_waitcnt vmcnt(15) lgkmcnt(6)
    v_mfma_f32_32x32x16_bf16 v[4:19], v[124:127], v[84:87], v[4:19]
    v_max3_u32 v246, v246, v84, v85
    v_max3_u32 v246, v246, v86, v87
    ds_read_b128 v[68:71], v254 offset:1024
    s_waitcnt lgkmcnt(6)
    v_mfma_f32_32x32x16_bf16 v[20:35], v[128:131], v[84:87], v[20:35]
    ds_read_b128 v[72:75], v254 offset:2048
    s_waitcnt lgkmcnt(6)
    v_mfma_f32_32x32x16_bf16 v[36:51], v[132:135], v[84:87], v[36:51]
    buffer_load_dwordx4 v[84:87], v2, s[12:15], s45 offen offset:2048 sc1
    ds_read_b128 v[124:127], v254 offset:3072
    s_waitcnt vmcnt(15) lgkmcnt(6)
    v_mfma_f32_32x32x16_bf16 v[4:19], v[52:55], v[88:91], v[4:19]
    v_max3_u32 v246, v246, v88, v89
    v_max3_u32 v246, v246, v90, v91
    ds_read_b128 v[128:131], v254 offset:4096
    s_waitcnt lgkmcnt(6)
    v_mfma_f32_32x32x16_bf16 v[20:35], v[56:59], v[88:91], v[20:35]
    ds_read_b128 v[132:135], v254 offset:5120
    s_waitcnt lgkmcnt(6)
    v_mfma_f32_32x32x16_bf16 v[36:51], v[60:63], v[88:91], v[36:51]
    buffer_load_dwordx4 v[88:91], v2, s[12:15], s45 offen offset:3072 sc1
    ds_read_b128 v[52:55], v254 offset:6144
    s_waitcnt vmcnt(15) lgkmcnt(6)
    v_mfma_f32_32x32x16_bf16 v[4:19], v[64:67], v[92:95], v[4:19]
    v_max3_u32 v246, v246, v92, v93
    v_max3_u32 v246, v246, v94, v95
    ds_read_b128 v[56:59], v254 offset:7168
    s_waitcnt lgkmcnt(6)
    v_mfma_f32_32x32x16_bf16 v[20:35], v[68:71], v[92:95], v[20:35]
    ds_read_b128 v[60:63], v254 offset:8192
    s_waitcnt lgkmcnt(6)
    v_mfma_f32_32x32x16_bf16 v[36:51], v[72:75], v[92:95], v[36:51]
    s_add_u32 s45, s45, 4096
    buffer_load_dwordx4 v[92:95], v2, s[12:15], s45 offen offset:0 sc1
    ds_read_b128 v[64:67], v254 offset:9216
    s_waitcnt vmcnt(15) lgkmcnt(6)
    v_mfma_f32_32x32x16_bf16 v[4:19], v[124:127], v[96:99], v[4:19]
    v_max3_u32 v246, v246, v96, v97
    v_max3_u32 v246, v246, v98, v99
    ds_read_b128 v[68:71], v254 offset:10240
    s_waitcnt lgkmcnt(6)
    v_mfma_f32_32x32x16_bf16 v[20:35], v[128:131], v[96:99], v[20:35]
    ds_read_b128 v[72:75], v254 offset:11264
    s_waitcnt lgkmcnt(6)
    v_mfma_f32_32x32x16_bf16 v[36:51], v[132:135], v[96:99], v[36:51]
    buffer_load_dwordx4 v[96:99], v2, s[12:15], s45 offen offset:1024 sc1
    ds_read_b128 v[124:127], v254 offset:12288
    s_waitcnt vmcnt(15) lgkmcnt(6)
    v_mfma_f32_32x32x16_bf16 v[4:19], v[52:55], v[100:103], v[4:19]
    v_max3_u32 v246, v246, v100, v101
    v_max3_u32 v246, v246, v102, v103
    ds_read_b128 v[128:131], v254 offset:13312
    s_waitcnt lgkmcnt(6)
    v_mfma_f32_32x32x16_bf16 v[20:35], v[56:59], v[100:103], v[20:35]
    ds_read_b128 v[132:135], v254 offset:14336
    s_waitcnt lgkmcnt(6)
    v_mfma_f32_32x32x16_bf16 v[36:51], v[60:63], v[100:103], v[36:51]
    buffer_load_dwordx4 v[100:103], v2, s[12:15], s45 offen offset:2048 sc1
    ds_read_b128 v[52:55], v254 offset:15360
    s_waitcnt vmcnt(15) lgkmcnt(6)
    v_mfma_f32_32x32x16_bf16 v[4:19], v[64:67], v[104:107], v[4:19]
    v_max3_u32 v246, v246, v104, v105
    v_max3_u32 v246, v246, v106, v107
    ds_read_b128 v[56:59], v254 offset:16384
    s_waitcnt lgkmcnt(6)
    v_mfma_f32_32x32x16_bf16 v[20:35], v[68:71], v[104:107], v[20:35]
    ds_read_b128 v[60:63], v254 offset:17408
    s_waitcnt lgkmcnt(6)
    v_mfma_f32_32x32x16_bf16 v[36:51], v[72:75], v[104:107], v[36:51]
    buffer_load_dwordx4 v[104:107], v2, s[12:15], s45 offen offset:3072 sc1
    ds_read_b128 v[64:67], v254 offset:18432
    s_waitcnt vmcnt(15) lgkmcnt(6)
    v_mfma_f32_32x32x16_bf16 v[4:19], v[124:127], v[108:111], v[4:19]
    v_max3_u32 v246, v246, v108, v109
    v_max3_u32 v246, v246, v110, v111
    ds_read_b128 v[68:71], v254 offset:19456
    s_waitcnt lgkmcnt(6)
    v_mfma_f32_32x32x16_bf16 v[20:35], v[128:131], v[108:111], v[20:35]
    ds_read_b128 v[72:75], v254 offset:20480
    s_waitcnt lgkmcnt(6)
    v_mfma_f32_32x32x16_bf16 v[36:51], v[132:135], v[108:111], v[36:51]
    ds_read_b128 v[124:127], v254 offset:21504
    s_waitcnt vmcnt(10) lgkmcnt(6)
    v_mfma_f32_32x32x16_bf16 v[4:19], v[52:55], v[112:115], v[4:19]
    v_max3_u32 v246, v246, v112, v113
    v_max3_u32 v246, v246, v114, v115
    ds_read_b128 v[128:131], v254 offset:22528
    s_waitcnt lgkmcnt(6)
    v_mfma_f32_32x32x16_bf16 v[20:35], v[56:59], v[112:115], v[20:35]
    ds_read_b128 v[132:135], v254 offset:23552
    s_waitcnt lgkmcnt(6)
    v_mfma_f32_32x32x16_bf16 v[36:51], v[60:63], v[112:115], v[36:51]
    s_mov_b32 s41, 131072
    s_branch L_pchk_61
L_poll_59:
    buffer_load_dwordx4 v[136:139], v247, s[12:15], s47 offen offset:0 sc1
    buffer_load_dwordx4 v[140:143], v247, s[12:15], s47 offen offset:512 sc1
    buffer_load_dwordx4 v[144:147], v247, s[12:15], s47 offen offset:1024 sc1
    buffer_load_dwordx4 v[148:151], v247, s[12:15], s47 offen offset:1536 sc1
    s_waitcnt vmcnt(0)
L_pchk_61:
    v_cmp_ne_u32 vcc, s36, v137
    v_cmp_ne_u32 s[42:43], s36, v139
    s_or_b64 vcc, vcc, s[42:43]
    v_cmp_ne_u32 s[42:43], s36, v141
    s_or_b64 vcc, vcc, s[42:43]
    v_cmp_ne_u32 s[42:43], s36, v143
    s_or_b64 vcc, vcc, s[42:43]
    v_cmp_ne_u32 s[42:43], s36, v145
    s_or_b64 vcc, vcc, s[42:43]
    v_cmp_ne_u32 s[42:43], s36, v147
    s_or_b64 vcc, vcc, s[42:43]
    v_cmp_ne_u32 s[42:43], s36, v149
    s_or_b64 vcc, vcc, s[42:43]
    v_cmp_ne_u32 s[42:43], s36, v151
    s_or_b64 vcc, vcc, s[42:43]
    s_cbranch_vccz L_pdone_60
    s_sub_u32 s41, s41, 1
    s_cbranch_scc0 L_poll_59
L_pdone_60:
    v_add_f32 v136, v136, v140
    v_add_f32 v138, v138, v142
    v_add_f32 v136, v136, v144
    v_add_f32 v138, v138, v146
    v_add_f32 v136, v136, v148
    v_add_f32 v138, v138, v150
    v_mov_b32 v137, v136
    v_mov_b32 v139, v138
    s_nop 0
    v_permlane32_swap_b32 v137, v136
    v_permlane32_swap_b32 v139, v138
    v_add_f32 v136, v136, v137
    v_add_f32 v138, v138, v139
    v_mul_f32 v136, 0xbb000000, v136
    v_mul_f32 v137, v136, v136
    v_mov_b32 v139, 0x3b000000
    v_fma_f32 v245, v138, v139, -v137
    v_max_f32 v245, 0, v245
    v_add_f32 v245, 0x3727c5ac, v245
    v_rsq_f32 v244, v245
    v_and_b32 v140, 0xffff0000, v136
    v_sub_f32 v141, v136, v140
    v_cvt_pk_bf16_f32 v152, v140, v141
    v_cvt_pk_bf16_f32 v153, v140, v141
    v_mov_b32 v154, 0
    v_mov_b32 v155, 0
    v_mul_f32 v244, 0xbfb8aa3b, v244
    s_lshl_b32 s50, s37, 2
    s_and_b32 s51, s3, 3
    s_add_u32 s50, s50, s51
    s_lshl_b32 s50, s50, 1
    s_lshr_b32 s51, s3, 2
    s_add_u32 s50, s50, s51
    s_mul_i32 s50, s50, 86
    s_mul_i32 s51, s38, 3
    s_add_u32 s50, s50, s51
    s_lshl_b32 s50, s50, 10
    s_add_u32 s50, s50, 12582912
    s_cmp_ge_u32 s38, 29
    s_cselect_b32 s50, 1073741824, s50
    s_cmp_ge_u32 s38, 28
    s_cselect_b32 s51, 1073741824, s50
    ds_read_b128 v[52:55], v254 offset:24576
    s_waitcnt vmcnt(9) lgkmcnt(6)
    v_mfma_f32_32x32x16_bf16 v[4:19], v[64:67], v[116:119], v[4:19]
    v_max3_u32 v246, v246, v116, v117
    v_max3_u32 v246, v246, v118, v119
    ds_read_b128 v[56:59], v254 offset:27648
    s_waitcnt lgkmcnt(6)
    v_mfma_f32_32x32x16_bf16 v[20:35], v[68:71], v[116:119], v[20:35]
    ds_read_b128 v[60:63], v254 offset:30720
    s_waitcnt lgkmcnt(6)
    v_mfma_f32_32x32x16_bf16 v[36:51], v[72:75], v[116:119], v[36:51]
    ds_read_b128 v[64:67], v254 offset:33792
    s_waitcnt vmcnt(8) lgkmcnt(6)
    v_mfma_f32_32x32x16_bf16 v[4:19], v[124:127], v[120:123], v[4:19]
    v_max3_u32 v246, v246, v120, v121
    v_max3_u32 v246, v246, v122, v123
    ds_read_b128 v[68:71], v254 offset:36864
    s_waitcnt lgkmcnt(6)
    v_mfma_f32_32x32x16_bf16 v[20:35], v[128:131], v[120:123], v[20:35]
    s_waitcnt lgkmcnt(5)
    v_mfma_f32_32x32x16_bf16 v[36:51], v[132:135], v[120:123], v[36:51]
    s_waitcnt vmcnt(7)
    v_max3_u32 v246, v246, v76, v77
    v_max3_u32 v246, v246, v78, v79
    s_waitcnt vmcnt(6)
    v_max3_u32 v246, v246, v80, v81
    v_max3_u32 v246, v246, v82, v83
    s_waitcnt vmcnt(5)
    v_max3_u32 v246, v246, v84, v85
    v_max3_u32 v246, v246, v86, v87
    s_waitcnt vmcnt(4)
    v_max3_u32 v246, v246, v88, v89
    v_max3_u32 v246, v246, v90, v91
    s_waitcnt vmcnt(3)
    v_max3_u32 v246, v246, v92, v93
    v_max3_u32 v246, v246, v94, v95
    s_waitcnt vmcnt(2)
    v_max3_u32 v246, v246, v96, v97
    v_max3_u32 v246, v246, v98, v99
    s_waitcnt vmcnt(1)
    v_max3_u32 v246, v246, v100, v101
    v_max3_u32 v246, v246, v102, v103
    s_waitcnt vmcnt(0)
    v_max3_u32 v246, v246, v104, v105
    v_max3_u32 v246, v246, v106, v107
    v_cmp_eq_u32 vcc, -1, v246
    s_cbranch_vccnz L_dfix
L_dok:
    v_mov_b32 v3, 161548
    v_mov_b32 v246, 1
    s_mov_b64 exec, 1
    ds_add_u32 v3, v246
    s_mov_b64 exec, -1
    v_mov_b32 v144, 0
    v_mov_b32 v145, 0
    v_mov_b32 v146, 0
    s_mov_b64 exec, 0xffffffff
    ds_read_b32 v144, v253 offset:0
    ds_read_b32 v145, v253 offset:128
    ds_read_b32 v146, v253 offset:256
    s_mov_b64 exec, -1
    ds_read_b128 v[72:75], v254 offset:39936
    s_waitcnt lgkmcnt(9)
    v_mfma_f32_32x32x16_bf16 v[4:19], v[52:55], v[76:79], v[4:19]
    ds_read_b128 v[52:55], v254 offset:43008
    s_waitcnt lgkmcnt(9)
    v_mfma_f32_32x32x16_bf16 v[4:19], v[56:59], v[80:83], v[4:19]
    ds_read_b128 v[56:59], v254 offset:46080
    s_waitcnt lgkmcnt(9)
    v_mfma_f32_32x32x16_bf16 v[4:19], v[60:63], v[84:87], v[4:19]
    s_waitcnt lgkmcnt(5)
    v_and_b32 v148, 0xffff0000, v144
    v_sub_f32 v149, v144, v148
    v_cvt_pk_bf16_f32 v124, v148, v148
    v_cvt_pk_bf16_f32 v125, v149, v149
    v_mov_b32 v126, 0
    v_mov_b32 v127, 0
    ds_read_b128 v[60:63], v254 offset:25600
    v_mfma_f32_32x32x16_bf16 v[4:19], v[64:67], v[88:91], v[4:19]
    s_waitcnt lgkmcnt(5)
    v_and_b32 v148, 0xffff0000, v145
    v_sub_f32 v149, v145, v148
    v_cvt_pk_bf16_f32 v128, v148, v148
    v_cvt_pk_bf16_f32 v129, v149, v149
    v_mov_b32 v130, 0
    v_mov_b32 v131, 0
    ds_read_b128 v[64:67], v254 offset:28672
    v_mfma_f32_32x32x16_bf16 v[4:19], v[68:71], v[92:95], v[4:19]
    s_waitcnt lgkmcnt(5)
    v_and_b32 v148, 0xffff0000, v146
    v_sub_f32 v149, v146, v148
    v_cvt_pk_bf16_f32 v132, v148, v148
    v_cvt_pk_bf16_f32 v133, v149, v149
    v_mov_b32 v134, 0
    v_mov_b32 v135, 0
    ds_read_b128 v[68:71], v254 offset:31744
    s_waitcnt lgkmcnt(5)
    v_mfma_f32_32x32x16_bf16 v[4:19], v[72:75], v[96:99], v[4:19]
    ds_read_b128 v[72:75], v254 offset:34816
    s_waitcnt lgkmcnt(5)
    v_mfma_f32_32x32x16_bf16 v[4:19], v[52:55], v[100:103], v[4:19]
    ds_read_b128 v[52:55], v254 offset:37888
    s_waitcnt lgkmcnt(5)
    v_mfma_f32_32x32x16_bf16 v[4:19], v[56:59], v[104:107], v[4:19]
    v_mfma_f32_32x32x16_bf16 v[4:19], v[124:127], v[152:155], v[4:19]
    ds_read_b128 v[56:59], v254 offset:40960
    s_waitcnt lgkmcnt(5)
    v_mfma_f32_32x32x16_bf16 v[20:35], v[60:63], v[76:79], v[20:35]
    ds_read_b128 v[60:63], v254 offset:44032
    s_waitcnt lgkmcnt(5)
    v_mfma_f32_32x32x16_bf16 v[20:35], v[64:67], v[80:83], v[20:35]
    ds_read_b128 v[64:67], v254 offset:47104
    s_waitcnt lgkmcnt(5)
    v_mfma_f32_32x32x16_bf16 v[20:35], v[68:71], v[84:87], v[20:35]
    s_nop 2
    v_mul_f32 v136, v244, v4
    v_mul_f32 v137, v244, v5
    v_mul_f32 v138, v244, v6
    v_mul_f32 v139, v244, v7
    v_mul_f32 v140, v244, v8
    v_mul_f32 v141, v244, v9
    v_mul_f32 v142, v244, v10
    v_mul_f32 v143, v244, v11
    v_exp_f32 v136, v136
    v_exp_f32 v137, v137
    v_exp_f32 v138, v138
    ds_read_b128 v[68:71], v254 offset:26624
    s_waitcnt lgkmcnt(5)
    v_mfma_f32_32x32x16_bf16 v[20:35], v[72:75], v[88:91], v[20:35]
    v_exp_f32 v139, v139
    v_exp_f32 v140, v140
    v_exp_f32 v141, v141
    v_exp_f32 v142, v142
    v_exp_f32 v143, v143
    v_mul_f32 v4, v4, v12
    v_mul_f32 v5, v5, v13
    v_mul_f32 v6, v6, v14
    v_mul_f32 v7, v7, v15
    v_mul_f32 v8, v8, v16
    v_mul_f32 v9, v9, v17
    ds_read_b128 v[72:75], v254 offset:29696
    s_waitcnt lgkmcnt(5)
    v_mfma_f32_32x32x16_bf16 v[20:35], v[52:55], v[92:95], v[20:35]
    v_mul_f32 v10, v10, v18
    v_mul_f32 v11, v11, v19
    v_fma_f32 v136, v136, v245, v245
    v_fma_f32 v137, v137, v245, v245
    v_fma_f32 v138, v138, v245, v245
    v_fma_f32 v139, v139, v245, v245
    v_fma_f32 v140, v140, v245, v245
    v_fma_f32 v141, v141, v245, v245
    v_fma_f32 v142, v142, v245, v245
    v_fma_f32 v143, v143, v245, v245
    v_rcp_f32 v136, v136
    ds_read_b128 v[52:55], v254 offset:32768
    s_waitcnt lgkmcnt(5)
    v_mfma_f32_32x32x16_bf16 v[20:35], v[56:59], v[96:99], v[20:35]
    v_rcp_f32 v137, v137
    v_rcp_f32 v138, v138
    v_rcp_f32 v139, v139
    v_rcp_f32 v140, v140
    v_rcp_f32 v141, v141
    v_rcp_f32 v142, v142
    v_rcp_f32 v143, v143
    v_mul_f32 v4, v4, v136
    v_mul_f32 v5, v5, v137
    v_mul_f32 v6, v6, v138
    v_mul_f32 v7, v7, v139
    ds_read_b128 v[56:59], v254 offset:35840
    s_waitcnt lgkmcnt(5)
    v_mfma_f32_32x32x16_bf16 v[20:35], v[60:63], v[100:103], v[20:35]
    v_mul_f32 v8, v8, v140
    v_mul_f32 v9, v9, v141
    v_mul_f32 v10, v10, v142
    v_mul_f32 v11, v11, v143
    v_cvt_pk_bf16_f32 v12, v4, v5
    v_cvt_pk_bf16_f32 v13, v6, v7
    v_cvt_pk_bf16_f32 v14, v8, v9
    v_cvt_pk_bf16_f32 v15, v10, v11
    v_min_u32 v12, -2, v12
    v_min_u32 v13, -2, v13
    v_min_u32 v14, -2, v14
    ds_read_b128 v[60:63], v254 offset:38912
    s_waitcnt lgkmcnt(5)
    v_mfma_f32_32x32x16_bf16 v[20:35], v[64:67], v[104:107], v[20:35]
    v_mfma_f32_32x32x16_bf16 v[20:35], v[128:131], v[152:155], v[20:35]
    v_min_u32 v15, -2, v15
    s_cmp_lg_u32 s39, 0
    s_cbranch_scc1 L_fast_62
    buffer_store_dwordx4 v[12:15], v2, s[12:15], s50 offen offset:0 sc1
    s_branch L_fdone_63
L_fast_62:
    buffer_store_dwordx4 v[12:15], v2, s[12:15], s50 offen offset:0
L_fdone_63:
    ds_read_b128 v[64:67], v254 offset:41984
    s_waitcnt lgkmcnt(5)
    v_mfma_f32_32x32x16_bf16 v[36:51], v[68:71], v[76:79], v[36:51]
    ds_read_b128 v[68:71], v254 offset:45056
    s_waitcnt lgkmcnt(5)
    v_mfma_f32_32x32x16_bf16 v[36:51], v[72:75], v[80:83], v[36:51]
    ds_read_b128 v[72:75], v254 offset:48128
    s_waitcnt lgkmcnt(5)
    v_mfma_f32_32x32x16_bf16 v[36:51], v[52:55], v[84:87], v[36:51]
    v_mul_f32 v144, v244, v20
    v_mul_f32 v145, v244, v21
    v_mul_f32 v146, v244, v22
    v_mul_f32 v147, v244, v23
    v_mul_f32 v148, v244, v24
    v_mul_f32 v149, v244, v25
    v_mul_f32 v150, v244, v26
    v_mul_f32 v151, v244, v27
    v_exp_f32 v144, v144
    v_exp_f32 v145, v145
    v_exp_f32 v146, v146
    s_waitcnt lgkmcnt(4)
    v_mfma_f32_32x32x16_bf16 v[36:51], v[56:59], v[88:91], v[36:51]
    v_exp_f32 v147, v147
    v_exp_f32 v148, v148
    v_exp_f32 v149, v149
    v_exp_f32 v150, v150
    v_exp_f32 v151, v151
    v_mul_f32 v20, v20, v28
    v_mul_f32 v21, v21, v29
    v_mul_f32 v22, v22, v30
    v_mul_f32 v23, v23, v31
    v_mul_f32 v24, v24, v32
    v_mul_f32 v25, v25, v33
    s_waitcnt lgkmcnt(3)
    v_mfma_f32_32x32x16_bf16 v[36:51], v[60:63], v[92:95], v[36:51]
    v_mul_f32 v26, v26, v34
    v_mul_f32 v27, v27, v35
    v_fma_f32 v144, v144, v245, v245
    v_fma_f32 v145, v145, v245, v245
    v_fma_f32 v146, v146, v245, v245
    v_fma_f32 v147, v147, v245, v245
    v_fma_f32 v148, v148, v245, v245
    v_fma_f32 v149, v149, v245, v245
    v_fma_f32 v150, v150, v245, v245
    v_fma_f32 v151, v151, v245, v245
    v_rcp_f32 v144, v144
    s_waitcnt lgkmcnt(2)
    v_mfma_f32_32x32x16_bf16 v[36:51], v[64:67], v[96:99], v[36:51]
    v_rcp_f32 v145, v145
    v_rcp_f32 v146, v146
    v_rcp_f32 v147, v147
    v_rcp_f32 v148, v148
    v_rcp_f32 v149, v149
    v_rcp_f32 v150, v150
    v_rcp_f32 v151, v151
    v_mul_f32 v20, v20, v144
    v_mul_f32 v21, v21, v145
    v_mul_f32 v22, v22, v146
    v_mul_f32 v23, v23, v147
    s_waitcnt lgkmcnt(1)
    v_mfma_f32_32x32x16_bf16 v[36:51], v[68:71], v[100:103], v[36:51]
    v_mul_f32 v24, v24, v148
    v_mul_f32 v25, v25, v149
    v_mul_f32 v26, v26, v150
    v_mul_f32 v27, v27, v151
    v_cvt_pk_bf16_f32 v28, v20, v21
    v_cvt_pk_bf16_f32 v29, v22, v23
    v_cvt_pk_bf16_f32 v30, v24, v25
    v_cvt_pk_bf16_f32 v31, v26, v27
    v_min_u32 v28, -2, v28
    v_min_u32 v29, -2, v29
    v_min_u32 v30, -2, v30
    s_waitcnt lgkmcnt(0)
    v_mfma_f32_32x32x16_bf16 v[36:51], v[72:75], v[104:107], v[36:51]
    v_mfma_f32_32x32x16_bf16 v[36:51], v[132:135], v[152:155], v[36:51]
    v_min_u32 v31, -2, v31
    s_cmp_lg_u32 s39, 0
    s_cbranch_scc1 L_fast_64
    buffer_store_dwordx4 v[28:31], v2, s[12:15], s50 offen offset:1024 sc1
    s_branch L_fdone_65
L_fast_64:
    buffer_store_dwordx4 v[28:31], v2, s[12:15], s50 offen offset:1024
L_fdone_65:
    s_nop 7
    v_mul_f32 v136, v244, v36
    v_mul_f32 v137, v244, v37
    v_mul_f32 v138, v244, v38
    v_mul_f32 v139, v244, v39
    v_mul_f32 v140, v244, v40
    v_mul_f32 v141, v244, v41
    v_mul_f32 v142, v244, v42
    v_mul_f32 v143, v244, v43
    v_exp_f32 v136, v136
    v_exp_f32 v137, v137
    v_exp_f32 v138, v138
    v_exp_f32 v139, v139
    v_exp_f32 v140, v140
    v_exp_f32 v141, v141
    v_exp_f32 v142, v142
    v_exp_f32 v143, v143
    v_mul_f32 v36, v36, v44
    v_mul_f32 v37, v37, v45
    v_mul_f32 v38, v38, v46
    v_mul_f32 v39, v39, v47
    v_mul_f32 v40, v40, v48
    v_mul_f32 v41, v41, v49
    v_mul_f32 v42, v42, v50
    v_mul_f32 v43, v43, v51
    v_fma_f32 v136, v136, v245, v245
    v_fma_f32 v137, v137, v245, v245
    v_fma_f32 v138, v138, v245, v245
    v_fma_f32 v139, v139, v245, v245
    v_fma_f32 v140, v140, v245, v245
    v_fma_f32 v141, v141, v245, v245
    v_fma_f32 v142, v142, v245, v245
    v_fma_f32 v143, v143, v245, v245
    v_rcp_f32 v136, v136
    v_rcp_f32 v137, v137
    v_rcp_f32 v138, v138
    v_rcp_f32 v139, v139
    v_rcp_f32 v140, v140
    v_rcp_f32 v141, v141
    v_rcp_f32 v142, v142
    v_rcp_f32 v143, v143
    v_mul_f32 v36, v36, v136
    v_mul_f32 v37, v37, v137
    v_mul_f32 v38, v38, v138
    v_mul_f32 v39, v39, v139
    v_mul_f32 v40, v40, v140
    v_mul_f32 v41, v41, v141
    v_mul_f32 v42, v42, v142
    v_mul_f32 v43, v43, v143
    v_cvt_pk_bf16_f32 v44, v36, v37
    v_cvt_pk_bf16_f32 v45, v38, v39
    v_cvt_pk_bf16_f32 v46, v40, v41
    v_cvt_pk_bf16_f32 v47, v42, v43
    v_min_u32 v44, -2, v44
    v_min_u32 v45, -2, v45
    v_min_u32 v46, -2, v46
    v_min_u32 v47, -2, v47
    s_cmp_lg_u32 s39, 0
    s_cbranch_scc1 L_fast_66
    buffer_store_dwordx4 v[44:47], v2, s[12:15], s51 offen offset:2048 sc1
    s_branch L_fdone_67
L_fast_66:
    buffer_store_dwordx4 v[44:47], v2, s[12:15], s51 offen offset:2048
L_fdone_67:
    s_setprio 0
L_djoin:
    s_mul_i32 s46, s3, 11
    s_and_b32 s50, s60, 0xfffffffe
    s_mul_i32 s50, s50, 86
    s_add_u32 s53, s50, 85
    s_add_u32 s50, s50, s46
    s_lshl_b32 s50, s50, 10
    s_lshl_b32 s53, s53, 10
    s_add_u32 s50, s50, 12582912
    s_add_u32 s53, s53, 12582912
    s_add_u32 s51, s50, 4096
    s_add_u32 s52, s50, 8192
    s_add_u32 s96, s50, 9216
    s_min_u32 s96, s96, s53
    s_add_u32 s97, s50, 10240
    s_min_u32 s97, s97, s53
    s_and_b32 s54, s60, 0xfffffffe
    s_add_u32 s54, s54, 1
    s_mul_i32 s54, s54, 86
    s_add_u32 s57, s54, 85
    s_add_u32 s54, s54, s46
    s_lshl_b32 s54, s54, 10
    s_lshl_b32 s57, s57, 10
    s_add_u32 s54, s54, 12582912
    s_add_u32 s57, s57, 12582912
    s_add_u32 s55, s54, 4096
    s_add_u32 s56, s54, 8192
    s_add_u32 s98, s54, 9216
    s_min_u32 s98, s98, s57
    s_add_u32 s99, s54, 10240
    s_min_u32 s99, s99, s57
    s_sub_u32 s44, s97, s50
    v_lshlrev_b32 v254, 10, v1
    v_min_u32 v254, s44, v254
    s_mov_b32 s101, 16
    s_lshr_b32 s46, s3, 1
    s_and_b32 s47, s3, 1
    v_mov_b32 v253, 0
    s_mov_b32 s41, 131072
L_spoll_68:
    s_mov_b64 exec, 0x7ff
    buffer_load_dword v253, v254, s[12:15], s50 offen offset:1020 sc1
    s_mov_b64 exec, -1
    buffer_load_dwordx4 v[4:7], v2, s[12:15], s50 offen offset:0 sc1
    buffer_load_dwordx4 v[8:11], v2, s[12:15], s50 offen offset:1024 sc1
    buffer_load_dwordx4 v[12:15], v2, s[12:15], s50 offen offset:2048 sc1
    s_waitcnt vmcnt(0)
    v_cmp_eq_u32 vcc, -1, v253
    s_cbranch_vccz L_sdone_69
    s_sub_u32 s41, s41, 1
    s_cbranch_scc0 L_spoll_68
L_sdone_69:
    buffer_load_dwordx4 v[16:19], v2, s[12:15], s50 offen offset:3072 sc1
    buffer_load_dwordx4 v[20:23], v2, s[12:15], s51 offen offset:0 sc1
    buffer_load_dwordx4 v[24:27], v2, s[12:15], s51 offen offset:1024 sc1
    buffer_load_dwordx4 v[28:31], v2, s[12:15], s51 offen offset:2048 sc1
    buffer_load_dwordx4 v[32:35], v2, s[12:15], s51 offen offset:3072 sc1
    buffer_load_dwordx4 v[36:39], v2, s[12:15], s52 offen offset:0 sc1
    buffer_load_dwordx4 v[40:43], v2, s[12:15], s96 offen sc1
    buffer_load_dwordx4 v[44:47], v2, s[12:15], s97 offen sc1
L_eredo0:
    v_mfma_f32_32x32x16_bf16 v[92:107], v[156:159], v[4:7], 0
    v_max3_u32 v255, v4, v5, v6
    v_max_u32 v255, v255, v7
    v_mfma_f32_32x32x16_bf16 v[108:123], v[160:163], v[4:7], 0
    v_mfma_f32_32x32x16_bf16 v[92:107], v[164:167], v[8:11], v[92:107]
    v_max3_u32 v255, v255, v8, v9
    v_max3_u32 v255, v255, v10, v11
    v_mfma_f32_32x32x16_bf16 v[108:123], v[168:171], v[8:11], v[108:123]
    v_mfma_f32_32x32x16_bf16 v[92:107], v[172:175], v[12:15], v[92:107]
    v_max3_u32 v255, v255, v12, v13
    v_max3_u32 v255, v255, v14, v15
    v_mfma_f32_32x32x16_bf16 v[108:123], v[176:179], v[12:15], v[108:123]
    s_waitcnt vmcnt(7)
    v_mfma_f32_32x32x16_bf16 v[92:107], v[180:183], v[16:19], v[92:107]
    v_max3_u32 v255, v255, v16, v17
    v_max3_u32 v255, v255, v18, v19
    v_mfma_f32_32x32x16_bf16 v[108:123], v[184:187], v[16:19], v[108:123]
    s_waitcnt vmcnt(6)
    v_mfma_f32_32x32x16_bf16 v[92:107], v[188:191], v[20:23], v[92:107]
    v_max3_u32 v255, v255, v20, v21
    v_max3_u32 v255, v255, v22, v23
    v_mfma_f32_32x32x16_bf16 v[108:123], v[192:195], v[20:23], v[108:123]
    s_mov_b64 exec, 0x7ff
    buffer_load_dword v253, v254, s[12:15], s54 offen offset:1020 sc1
    s_mov_b64 exec, -1
    s_waitcnt vmcnt(6)
    v_mfma_f32_32x32x16_bf16 v[92:107], v[196:199], v[24:27], v[92:107]
    v_max3_u32 v255, v255, v24, v25
    v_max3_u32 v255, v255, v26, v27
    v_mfma_f32_32x32x16_bf16 v[108:123], v[200:203], v[24:27], v[108:123]
    s_waitcnt vmcnt(5)
    v_mfma_f32_32x32x16_bf16 v[92:107], v[204:207], v[28:31], v[92:107]
    v_max3_u32 v255, v255, v28, v29
    v_max3_u32 v255, v255, v30, v31
    v_mfma_f32_32x32x16_bf16 v[108:123], v[208:211], v[28:31], v[108:123]
    s_waitcnt vmcnt(4)
    v_mfma_f32_32x32x16_bf16 v[92:107], v[212:215], v[32:35], v[92:107]
    v_max3_u32 v255, v255, v32, v33
    v_max3_u32 v255, v255, v34, v35
    v_mfma_f32_32x32x16_bf16 v[108:123], v[216:219], v[32:35], v[108:123]
    s_waitcnt vmcnt(3)
    v_mfma_f32_32x32x16_bf16 v[92:107], v[220:223], v[36:39], v[92:107]
    v_max3_u32 v255, v255, v36, v37
    v_max3_u32 v255, v255, v38, v39
    v_mfma_f32_32x32x16_bf16 v[108:123], v[224:227], v[36:39], v[108:123]
    s_waitcnt vmcnt(2)
    v_mfma_f32_32x32x16_bf16 v[92:107], v[228:231], v[40:43], v[92:107]
    v_max3_u32 v255, v255, v40, v41
    v_max3_u32 v255, v255, v42, v43
    v_mfma_f32_32x32x16_bf16 v[108:123], v[232:235], v[40:43], v[108:123]
    s_waitcnt vmcnt(1)
    v_mfma_f32_32x32x16_bf16 v[92:107], v[236:239], v[44:47], v[92:107]
    v_max3_u32 v255, v255, v44, v45
    v_max3_u32 v255, v255, v46, v47
    v_mfma_f32_32x32x16_bf16 v[108:123], v[240:243], v[44:47], v[108:123]
    v_cmp_eq_u32 vcc, -1, v255
    s_cbranch_vccnz L_efix0
L_eok0:
    s_waitcnt vmcnt(0)
    v_cmp_eq_u32 vcc, -1, v253
    s_cbranch_vccz L_ego_72
    s_mov_b32 s41, 131072
L_spoll_73:
    s_mov_b64 exec, 0x7ff
    buffer_load_dword v253, v254, s[12:15], s54 offen offset:1020 sc1
    s_mov_b64 exec, -1
    s_waitcnt vmcnt(0)
    v_cmp_eq_u32 vcc, -1, v253
    s_cbranch_vccz L_sdone_74
    s_sub_u32 s41, s41, 1
    s_cbranch_scc0 L_spoll_73
L_sdone_74:
L_ego_72:
    buffer_load_dwordx4 v[48:51], v2, s[12:15], s54 offen offset:0 sc1
    buffer_load_dwordx4 v[52:55], v2, s[12:15], s54 offen offset:1024 sc1
    buffer_load_dwordx4 v[56:59], v2, s[12:15], s54 offen offset:2048 sc1
    buffer_load_dwordx4 v[60:63], v2, s[12:15], s54 offen offset:3072 sc1
    buffer_load_dwordx4 v[64:67], v2, s[12:15], s55 offen offset:0 sc1
    buffer_load_dwordx4 v[68:71], v2, s[12:15], s55 offen offset:1024 sc1
    buffer_load_dwordx4 v[72:75], v2, s[12:15], s55 offen offset:2048 sc1
    buffer_load_dwordx4 v[76:79], v2, s[12:15], s55 offen offset:3072 sc1
    buffer_load_dwordx4 v[80:83], v2, s[12:15], s56 offen offset:0 sc1
    buffer_load_dwordx4 v[84:87], v2, s[12:15], s98 offen sc1
    buffer_load_dwordx4 v[88:91], v2, s[12:15], s99 offen sc1
L_eredo1:
    s_waitcnt vmcnt(10)
    v_mfma_f32_32x32x16_bf16 v[124:139], v[156:159], v[48:51], 0
    v_max3_u32 v255, v48, v49, v50
    v_max_u32 v255, v255, v51
    v_mfma_f32_32x32x16_bf16 v[140:155], v[160:163], v[48:51], 0
    s_waitcnt vmcnt(9)
    v_mfma_f32_32x32x16_bf16 v[124:139], v[164:167], v[52:55], v[124:139]
    v_max3_u32 v255, v255, v52, v53
    v_max3_u32 v255, v255, v54, v55
    v_mfma_f32_32x32x16_bf16 v[140:155], v[168:171], v[52:55], v[140:155]
    s_xor_b32 s45, s47, 0
    s_cmp_eq_u32 s45, 0
    s_cbranch_scc1 L_own_76
    s_xor_b32 s44, s46, 0
    s_mul_i32 s44, s44, 7
    s_add_u32 s44, s44, s45
    s_lshl_b32 s44, s44, 11
    s_add_u32 s44, s44, 96256
    v_add_u32 v244, s44, v2
    ds_write_b128 v244, v[92:95]
    ds_write_b128 v244, v[96:99] offset:1024
L_own_76:
    s_waitcnt vmcnt(8)
    v_mfma_f32_32x32x16_bf16 v[124:139], v[172:175], v[56:59], v[124:139]
    v_max3_u32 v255, v255, v56, v57
    v_max3_u32 v255, v255, v58, v59
    v_mfma_f32_32x32x16_bf16 v[140:155], v[176:179], v[56:59], v[140:155]
    s_waitcnt vmcnt(7)
    v_mfma_f32_32x32x16_bf16 v[124:139], v[180:183], v[60:63], v[124:139]
    v_max3_u32 v255, v255, v60, v61
    v_max3_u32 v255, v255, v62, v63
    v_mfma_f32_32x32x16_bf16 v[140:155], v[184:187], v[60:63], v[140:155]
    s_xor_b32 s45, s47, 0
    s_xor_b32 s44, s46, 1
    s_mul_i32 s44, s44, 7
    s_add_u32 s44, s44, s45
    s_lshl_b32 s44, s44, 11
    s_add_u32 s44, s44, 100352
    v_add_u32 v245, s44, v2
    ds_write_b128 v245, v[100:103]
    ds_write_b128 v245, v[104:107] offset:1024
    s_waitcnt vmcnt(6)
    v_mfma_f32_32x32x16_bf16 v[124:139], v[188:191], v[64:67], v[124:139]
    v_max3_u32 v255, v255, v64, v65
    v_max3_u32 v255, v255, v66, v67
    v_mfma_f32_32x32x16_bf16 v[140:155], v[192:195], v[64:67], v[140:155]
    s_waitcnt vmcnt(5)
    v_mfma_f32_32x32x16_bf16 v[124:139], v[196:199], v[68:71], v[124:139]
    v_max3_u32 v255, v255, v68, v69
    v_max3_u32 v255, v255, v70, v71
    v_mfma_f32_32x32x16_bf16 v[140:155], v[200:203], v[68:71], v[140:155]
    s_xor_b32 s45, s47, 0
    s_xor_b32 s44, s46, 2
    s_mul_i32 s44, s44, 7
    s_add_u32 s44, s44, s45
    s_lshl_b32 s44, s44, 11
    s_add_u32 s44, s44, 104448
    v_add_u32 v246, s44, v2
    ds_write_b128 v246, v[108:111]
    ds_write_b128 v246, v[112:115] offset:1024
    s_waitcnt vmcnt(4)
    v_mfma_f32_32x32x16_bf16 v[124:139], v[204:207], v[72:75], v[124:139]
    v_max3_u32 v255, v255, v72, v73
    v_max3_u32 v255, v255, v74, v75
    v_mfma_f32_32x32x16_bf16 v[140:155], v[208:211], v[72:75], v[140:155]
    s_waitcnt vmcnt(3)
    v_mfma_f32_32x32x16_bf16 v[124:139], v[212:215], v[76:79], v[124:139]
    v_max3_u32 v255, v255, v76, v77
    v_max3_u32 v255, v255, v78, v79
    v_mfma_f32_32x32x16_bf16 v[140:155], v[216:219], v[76:79], v[140:155]
    s_xor_b32 s45, s47, 0
    s_xor_b32 s44, s46, 3
    s_mul_i32 s44, s44, 7
    s_add_u32 s44, s44, s45
    s_lshl_b32 s44, s44, 11
    s_add_u32 s44, s44, 108544
    v_add_u32 v247, s44, v2
    ds_write_b128 v247, v[116:119]
    ds_write_b128 v247, v[120:123] offset:1024
    s_waitcnt vmcnt(2)
    v_mfma_f32_32x32x16_bf16 v[124:139], v[220:223], v[80:83], v[124:139]
    v_max3_u32 v255, v255, v80, v81
    v_max3_u32 v255, v255, v82, v83
    v_mfma_f32_32x32x16_bf16 v[140:155], v[224:227], v[80:83], v[140:155]
    s_waitcnt vmcnt(1)
    v_mfma_f32_32x32x16_bf16 v[124:139], v[228:231], v[84:87], v[124:139]
    v_max3_u32 v255, v255, v84, v85
    v_max3_u32 v255, v255, v86, v87
    v_mfma_f32_32x32x16_bf16 v[140:155], v[232:235], v[84:87], v[140:155]
    s_waitcnt vmcnt(0)
    v_mfma_f32_32x32x16_bf16 v[124:139], v[236:239], v[88:91], v[124:139]
    v_max3_u32 v255, v255, v88, v89
    v_max3_u32 v255, v255, v90, v91
    v_mfma_f32_32x32x16_bf16 v[140:155], v[240:243], v[88:91], v[140:155]
    v_cmp_eq_u32 vcc, -1, v255
    s_cbranch_vccnz L_efix1
L_eok1:
    v_mov_b32 v3, 161548
    s_mov_b32 s41, 1048576
L_cn2_80:
    ds_read_b32 v253, v3
    s_waitcnt lgkmcnt(0)
    v_cmp_ne_u32 vcc, 8, v253
    s_cbranch_vccz L_cn2d_81
    s_sub_u32 s41, s41, 1
    s_cbranch_scc0 L_cn2_80
L_cn2d_81:
    v_lshlrev_b32 v4, 16, v248
    v_and_b32 v5, 0xffff0000, v248
    v_lshlrev_b32 v6, 16, v249
    v_and_b32 v7, 0xffff0000, v249
    v_lshlrev_b32 v8, 16, v250
    v_and_b32 v9, 0xffff0000, v250
    v_lshlrev_b32 v10, 16, v251
    v_and_b32 v11, 0xffff0000, v251
    s_mul_i32 s45, s46, 14336
    s_cmp_eq_u32 s47, 0
    s_cselect_b32 s44, 98304, 0
    s_add_u32 s45, s45, s44
    v_add_u32 v3, s45, v2
    s_xor_b32 s45, s47, 1
    s_xor_b32 s44, s46, 3
    s_mul_i32 s44, s44, 7
    s_add_u32 s44, s44, s45
    s_lshl_b32 s44, s44, 11
    s_add_u32 s44, s44, 10240
    v_add_u32 v247, s44, v2
    ds_write_b128 v247, v[148:151]
    ds_write_b128 v247, v[152:155] offset:1024
    s_xor_b32 s45, s47, 1
    s_xor_b32 s44, s46, 2
    s_mul_i32 s44, s44, 7
    s_add_u32 s44, s44, s45
    s_lshl_b32 s44, s44, 11
    s_add_u32 s44, s44, 6144
    v_add_u32 v246, s44, v2
    ds_write_b128 v246, v[140:143]
    ds_write_b128 v246, v[144:147] offset:1024
    s_xor_b32 s45, s47, 1
    s_xor_b32 s44, s46, 1
    s_mul_i32 s44, s44, 7
    s_add_u32 s44, s44, s45
    s_lshl_b32 s44, s44, 11
    s_add_u32 s44, s44, 2048
    v_add_u32 v245, s44, v2
    ds_write_b128 v245, v[132:135]
    ds_write_b128 v245, v[136:139] offset:1024
    s_xor_b32 s45, s47, 1
    s_cmp_eq_u32 s45, 0
    s_cbranch_scc1 L_own_85
    s_xor_b32 s44, s46, 0
    s_mul_i32 s44, s44, 7
    s_add_u32 s44, s44, s45
    s_lshl_b32 s44, s44, 11
    s_add_u32 s44, s44, 4294965248
    v_add_u32 v244, s44, v2
    ds_write_b128 v244, v[124:127]
    ds_write_b128 v244, v[128:131] offset:1024
L_own_85:
    s_cmp_lg_u32 s47, 0
    s_cbranch_scc1 L_odd_86
    v_add_f32 v92, v92, v4
    v_add_f32 v93, v93, v5
    v_add_f32 v94, v94, v6
    v_add_f32 v95, v95, v7
    v_add_f32 v96, v96, v8
    v_add_f32 v97, v97, v9
    v_add_f32 v98, v98, v10
    v_add_f32 v99, v99, v11
    s_branch L_sum_87
L_odd_86:
    v_add_f32 v92, v124, v4
    v_add_f32 v93, v125, v5
    v_add_f32 v94, v126, v6
    v_add_f32 v95, v127, v7
    v_add_f32 v96, v128, v8
    v_add_f32 v97, v129, v9
    v_add_f32 v98, v130, v10
    v_add_f32 v99, v131, v11
L_sum_87:
    s_waitcnt lgkmcnt(0)
    s_barrier
    ds_read_b128 v[4:7], v3 offset:0
    ds_read_b128 v[8:11], v3 offset:1024
    ds_read_b128 v[12:15], v3 offset:2048
    ds_read_b128 v[16:19], v3 offset:3072
    ds_read_b128 v[20:23], v3 offset:4096
    ds_read_b128 v[24:27], v3 offset:5120
    ds_read_b128 v[28:31], v3 offset:6144
    ds_read_b128 v[32:35], v3 offset:7168
    ds_read_b128 v[36:39], v3 offset:8192
    ds_read_b128 v[40:43], v3 offset:9216
    ds_read_b128 v[44:47], v3 offset:10240
    ds_read_b128 v[48:51], v3 offset:11264
    ds_read_b128 v[52:55], v3 offset:12288
    ds_read_b128 v[56:59], v3 offset:13312
    s_waitcnt lgkmcnt(13)
    v_add_f32 v92, v92, v4
    v_add_f32 v93, v93, v5
    v_add_f32 v94, v94, v6
    v_add_f32 v95, v95, v7
    s_waitcnt lgkmcnt(12)
    v_add_f32 v96, v96, v8
    v_add_f32 v97, v97, v9
    v_add_f32 v98, v98, v10
    v_add_f32 v99, v99, v11
    s_waitcnt lgkmcnt(11)
    v_add_f32 v92, v92, v12
    v_add_f32 v93, v93, v13
    v_add_f32 v94, v94, v14
    v_add_f32 v95, v95, v15
    s_waitcnt lgkmcnt(10)
    v_add_f32 v96, v96, v16
    v_add_f32 v97, v97, v17
    v_add_f32 v98, v98, v18
    v_add_f32 v99, v99, v19
    s_waitcnt lgkmcnt(9)
    v_add_f32 v92, v92, v20
    v_add_f32 v93, v93, v21
    v_add_f32 v94, v94, v22
    v_add_f32 v95, v95, v23
    s_waitcnt lgkmcnt(8)
    v_add_f32 v96, v96, v24
    v_add_f32 v97, v97, v25
    v_add_f32 v98, v98, v26
    v_add_f32 v99, v99, v27
    s_waitcnt lgkmcnt(7)
    v_add_f32 v92, v92, v28
    v_add_f32 v93, v93, v29
    v_add_f32 v94, v94, v30
    v_add_f32 v95, v95, v31
    s_waitcnt lgkmcnt(6)
    v_add_f32 v96, v96, v32
    v_add_f32 v97, v97, v33
    v_add_f32 v98, v98, v34
    v_add_f32 v99, v99, v35
    s_waitcnt lgkmcnt(5)
    v_add_f32 v92, v92, v36
    v_add_f32 v93, v93, v37
    v_add_f32 v94, v94, v38
    v_add_f32 v95, v95, v39
    s_waitcnt lgkmcnt(4)
    v_add_f32 v96, v96, v40
    v_add_f32 v97, v97, v41
    v_add_f32 v98, v98, v42
    v_add_f32 v99, v99, v43
    s_waitcnt lgkmcnt(3)
    v_add_f32 v92, v92, v44
    v_add_f32 v93, v93, v45
    v_add_f32 v94, v94, v46
    v_add_f32 v95, v95, v47
    s_waitcnt lgkmcnt(2)
    v_add_f32 v96, v96, v48
    v_add_f32 v97, v97, v49
    v_add_f32 v98, v98, v50
    v_add_f32 v99, v99, v51
    s_waitcnt lgkmcnt(1)
    v_add_f32 v92, v92, v52
    v_add_f32 v93, v93, v53
    v_add_f32 v94, v94, v54
    v_add_f32 v95, v95, v55
    s_waitcnt lgkmcnt(0)
    v_add_f32 v96, v96, v56
    v_add_f32 v97, v97, v57
    v_add_f32 v98, v98, v58
    v_add_f32 v99, v99, v59
    v_cvt_pk_bf16_f32 v4, v92, v93
    v_cvt_pk_bf16_f32 v5, v94, v95
    v_cvt_pk_bf16_f32 v6, v96, v97
    v_cvt_pk_bf16_f32 v7, v98, v99
    buffer_store_dwordx4 v[4:7], v252, s[32:35], s62 offen
    s_or_b32 s44, s2, s3
    s_cmp_lg_u32 s44, 0
    s_cbranch_scc1 L_nobump_88
    v_mov_b32 v3, s63
    s_mov_b64 exec, 1
    buffer_store_dword v3, off, s[12:15], 0 sc1
    s_waitcnt vmcnt(0)
L_nobump_88:
    s_endpgm
L_fallback:
    s_lshl_b32 s42, s58, 17
    s_add_u32 s42, s42, 4194304
    s_mov_b32 s43, s42
    v_mov_b32 v3, 0xff800000
    s_mov_b32 s44, 64
L_fb_max:
    buffer_load_dwordx4 v[56:59], v2, s[12:15], s43 offen sc1
    s_add_u32 s43, s43, 2048
    s_waitcnt vmcnt(0)
    v_mfma_f32_32x32x16_bf16 v[8:23], v[56:59], v[4:7], 0
    s_nop 11
    v_max3_f32 v3, v3, v8, v9
    v_max3_f32 v3, v3, v10, v11
    v_max3_f32 v3, v3, v12, v13
    v_max3_f32 v3, v3, v14, v15
    v_max3_f32 v3, v3, v16, v17
    v_max3_f32 v3, v3, v18, v19
    v_max3_f32 v3, v3, v20, v21
    v_max3_f32 v3, v3, v22, v23
    s_sub_u32 s44, s44, 1
    s_cmp_lg_u32 s44, 0
    s_cbranch_scc1 L_fb_max
    v_mov_b32 v24, v3
    s_nop 1
    v_permlane32_swap_b32 v24, v3
    v_max_f32 v3, v3, v24
    v_sub_f32 v24, 0, v3
    v_mov_b32 v40, 0
    v_sub_f32 v25, 0, v3
    v_mov_b32 v41, 0
    v_sub_f32 v26, 0, v3
    v_mov_b32 v42, 0
    v_sub_f32 v27, 0, v3
    v_mov_b32 v43, 0
    v_sub_f32 v28, 0, v3
    v_mov_b32 v44, 0
    v_sub_f32 v29, 0, v3
    v_mov_b32 v45, 0
    v_sub_f32 v30, 0, v3
    v_mov_b32 v46, 0
    v_sub_f32 v31, 0, v3
    v_mov_b32 v47, 0
    v_sub_f32 v32, 0, v3
    v_mov_b32 v48, 0
    v_sub_f32 v33, 0, v3
    v_mov_b32 v49, 0
    v_sub_f32 v34, 0, v3
    v_mov_b32 v50, 0
    v_sub_f32 v35, 0, v3
    v_mov_b32 v51, 0
    v_sub_f32 v36, 0, v3
    v_mov_b32 v52, 0
    v_sub_f32 v37, 0, v3
    v_mov_b32 v53, 0
    v_sub_f32 v38, 0, v3
    v_mov_b32 v54, 0
    v_sub_f32 v39, 0, v3
    v_mov_b32 v55, 0
    s_mov_b32 s44, 64
L_fb_pv:
    buffer_load_dwordx4 v[56:59], v2, s[12:15], s42 offen sc1
    s_mov_b64 exec, s[48:49]
    buffer_load_dwordx4 v[64:67], v82, s[12:15], s42 offen offset:0 sc1
    buffer_load_dwordx4 v[68:71], v82, s[12:15], s42 offen offset:512 sc1
    s_mov_b64 exec, -1
    s_add_u32 s42, s42, 2048
    s_waitcnt vmcnt(2)
    v_mfma_f32_32x32x16_bf16 v[8:23], v[56:59], v[4:7], v[24:39]
    s_nop 11
    v_exp_f32 v8, v8
    v_exp_f32 v9, v9
    v_exp_f32 v10, v10
    v_exp_f32 v11, v11
    v_exp_f32 v12, v12
    v_exp_f32 v13, v13
    v_exp_f32 v14, v14
    v_exp_f32 v15, v15
    v_exp_f32 v16, v16
    v_exp_f32 v17, v17
    v_exp_f32 v18, v18
    v_exp_f32 v19, v19
    v_exp_f32 v20, v20
    v_exp_f32 v21, v21
    v_exp_f32 v22, v22
    v_exp_f32 v23, v23
    s_waitcnt vmcnt(1)
    v_smfmac_f32_32x32x32_bf16 v[40:55], v[64:67], v[8:15], v80
    s_waitcnt vmcnt(0)
    v_smfmac_f32_32x32x32_bf16 v[40:55], v[68:71], v[16:23], v80
    s_nop 15
    s_nop 3
    s_sub_u32 s44, s44, 1
    s_cmp_lg_u32 s44, 0
    s_cbranch_scc1 L_fb_pv
    s_branch L_attn_fin
L_dfix:
    s_waitcnt vmcnt(0) lgkmcnt(0)
    s_nop 15
    s_nop 3
    s_sub_u32 s101, s101, 1
    s_cbranch_scc0 L_dredo
    s_branch L_dok
L_efix0:
    s_waitcnt vmcnt(0) lgkmcnt(0)
    s_nop 15
    s_nop 3
    s_sub_u32 s101, s101, 1
    s_cbranch_scc1 L_eok0
    buffer_load_dwordx4 v[4:7], v2, s[12:15], s50 offen offset:0 sc1
    buffer_load_dwordx4 v[8:11], v2, s[12:15], s50 offen offset:1024 sc1
    buffer_load_dwordx4 v[12:15], v2, s[12:15], s50 offen offset:2048 sc1
    buffer_load_dwordx4 v[16:19], v2, s[12:15], s50 offen offset:3072 sc1
    buffer_load_dwordx4 v[20:23], v2, s[12:15], s51 offen offset:0 sc1
    buffer_load_dwordx4 v[24:27], v2, s[12:15], s51 offen offset:1024 sc1
    buffer_load_dwordx4 v[28:31], v2, s[12:15], s51 offen offset:2048 sc1
    buffer_load_dwordx4 v[32:35], v2, s[12:15], s51 offen offset:3072 sc1
    buffer_load_dwordx4 v[36:39], v2, s[12:15], s52 offen offset:0 sc1
    buffer_load_dwordx4 v[40:43], v2, s[12:15], s96 offen sc1
    buffer_load_dwordx4 v[44:47], v2, s[12:15], s97 offen sc1
    s_waitcnt vmcnt(0)
    s_branch L_eredo0
L_efix1:
    s_waitcnt vmcnt(0) lgkmcnt(0)
    s_nop 15
    s_nop 3
    s_sub_u32 s101, s101, 1
    s_cbranch_scc1 L_eok1
    buffer_load_dwordx4 v[48:51], v2, s[12:15], s54 offen offset:0 sc1
    buffer_load_dwordx4 v[52:55], v2, s[12:15], s54 offen offset:1024 sc1
    buffer_load_dwordx4 v[56:59], v2, s[12:15], s54 offen offset:2048 sc1
    buffer_load_dwordx4 v[60:63], v2, s[12:15], s54 offen offset:3072 sc1
    buffer_load_dwordx4 v[64:67], v2, s[12:15], s55 offen offset:0 sc1
    buffer_load_dwordx4 v[68:71], v2, s[12:15], s55 offen offset:1024 sc1
    buffer_load_dwordx4 v[72:75], v2, s[12:15], s55 offen offset:2048 sc1
    buffer_load_dwordx4 v[76:79], v2, s[12:15], s55 offen offset:3072 sc1
    buffer_load_dwordx4 v[80:83], v2, s[12:15], s56 offen offset:0 sc1
    buffer_load_dwordx4 v[84:87], v2, s[12:15], s98 offen sc1
    buffer_load_dwordx4 v[88:91], v2, s[12:15], s99 offen sc1
    s_waitcnt vmcnt(0)
    s_branch L_eredo1
L_exit:
    s_endpgm
.section .rodata,"a"
.p2align 6
.amdhsa_kernel sequential_preLN__softmax_full_mha__glu_gated_swiglu__prompt_kernel
  .amdhsa_next_free_vgpr 256
  .amdhsa_next_free_sgpr 102
  .amdhsa_accum_offset 256
  .amdhsa_group_segment_fixed_size 0
  .amdhsa_kernarg_size 80
  .amdhsa_user_sgpr_count 2
  .amdhsa_user_sgpr_kernarg_segment_ptr 1
  .amdhsa_system_sgpr_workgroup_id_x 1
.end_amdhsa_kernel
```
